```python
import torch

def _softmax(x, axis=-1):
    return torch.softmax(x, dim=axis)
def _gelu(x):
    return torch.nn.functional.gelu(x, approximate="tanh")
def _silu(x):
    return torch.nn.functional.silu(x)
def _sigmoid(x):
    return torch.sigmoid(x)
def _layernorm(x, axis=-1, eps=1e-5):
    m = x.mean(dim=axis, keepdim=True)
    v = x.var(dim=axis, keepdim=True, unbiased=False)
    return (x - m) / torch.sqrt(v + eps)
def _scatter_add(tgt, idx, src, axis=0):
    return tgt.clone().index_add_(axis, idx, src)
def _segment_sum(src, seg, n):
    out = torch.zeros((n,) + src.shape[1:], dtype=src.dtype)
    return out.index_add_(0, seg, src)
def _pad(x, pw):
    flat = tuple(v for pair in reversed(pw) for v in pair)
    return torch.nn.functional.pad(x, flat)

kernel_name = 'parallel_sum__mha_block_cached__geglu_ffn__decode'

def setup_inputs():

    _w = (lambda a: (lambda t: t.to(torch.bfloat16) if t.is_floating_point() else t)(torch.as_tensor(a)))
    def _A_setup():
        B, Sq, D = 1, 1, 576
        H, Sk, Dh = 32, 16384, 128
        return {
            "x": _w((lambda *s: torch.randn(*s, dtype=torch.bfloat16) * 0.05)(B, Sq, D)),
            "k_cache": _w((lambda *s: torch.randn(*s, dtype=torch.bfloat16) * 3.2)(B, H, Sk, Dh)),
            "v_cache": _w((lambda *s: torch.randn(*s, dtype=torch.bfloat16) * 1.6)(B, H, Sk, Dh)),
            "wq": _w((lambda *s: torch.randn(*s, dtype=torch.bfloat16) * 3.2)(D, H * Dh) * (D ** -0.5)),
            "wo": _w((lambda *s: torch.randn(*s, dtype=torch.bfloat16) * 1.6)(H * Dh, D) * ((H * Dh) ** -0.5)),
        }
    _A_in = _A_setup()

    def _B_setup():
        B, S, D, F = 1, 1, 576, 4608
        return {
            "x": _w((lambda *s: torch.randn(*s, dtype=torch.bfloat16) * 0.05)(B, S, D)),
            "w_gate": _w((lambda *s: torch.randn(*s, dtype=torch.bfloat16) * 0.05)(D, F)),
            "w_up": _w((lambda *s: torch.randn(*s, dtype=torch.bfloat16) * 0.05)(D, F)),
            "w_down": _w((lambda *s: torch.randn(*s, dtype=torch.bfloat16) * 0.05)(F, D)),
        }
    _B_in = _B_setup()

    return {
        "A_x": _A_in["x"],
        "A_k_cache": _A_in["k_cache"],
        "A_v_cache": _A_in["v_cache"],
        "A_wq": _A_in["wq"],
        "A_wo": _A_in["wo"],
        "B_x": _B_in["x"],
        "B_w_gate": _B_in["w_gate"],
        "B_w_up": _B_in["w_up"],
        "B_w_down": _B_in["w_down"],
    }

def reference(A_x, A_k_cache, A_v_cache, A_wq, A_wo, B_x, B_w_gate, B_w_up, B_w_down):
    def _A_ref(x, k_cache, v_cache, wq, wo):
        B, Sq, D = x.shape
        H, Dh = 32, 128
        q = (lambda x, *d: x.permute(*d))((x @ wq).reshape(B, Sq, H, Dh), 0, 2, 1, 3)
        scores = torch.einsum("bhqd,bhkd->bhqk", q, k_cache) * (Dh ** -0.5)
        p = _softmax(scores, axis=-1)
        o = torch.einsum("bhqk,bhkd->bhqd", p, v_cache)
        return (lambda x, *d: x.permute(*d))(o, 0, 2, 1, 3).reshape(B, Sq, H * Dh) @ wo

    def _B_ref(x, w_gate, w_up, w_down):
        return (_gelu(x @ w_gate) * (x @ w_up)) @ w_down

    x = A_x
    xn = _layernorm(x, axis=-1)
    return x + _A_ref(xn, A_k_cache, A_v_cache, A_wq, A_wo) + _B_ref(xn, B_w_gate, B_w_up, B_w_down)
```

```asm
; @launch kernel=parallel_sum__mha_block_cached__geglu_ffn__decode_kernel grid=(256,1,1) block=(1024,1,1) lds=95232
; @launch kernel=psum_final_kernel grid=(144,1,1) block=(64,1,1) lds=0
.amdgcn_target "amdgcn-amd-amdhsa--gfx950"
.text
.globl parallel_sum__mha_block_cached__geglu_ffn__decode_kernel
.p2align 8
.type parallel_sum__mha_block_cached__geglu_ffn__decode_kernel,@function
parallel_sum__mha_block_cached__geglu_ffn__decode_kernel:
    s_cmp_ge_u32 s2, 256
    s_cbranch_scc1 L_k1_end
    s_load_dwordx16 s[4:19], s[0:1], 0
    s_load_dwordx8 s[20:27], s[0:1], 64
    v_and_b32 v2, 63, v0
    v_lshlrev_b32 v1, 4, v2
    v_lshrrev_b32 v3, 4, v2
    v_and_b32 v4, 15, v2
    v_lshrrev_b32 v5, 6, v0
    s_nop 0
    v_readfirstlane_b32 s64, v5
    s_and_b32 s65, s2, 7
    s_lshr_b32 s66, s2, 3
    s_lshr_b32 s67, s66, 2
    s_and_b32 s68, s66, 3
    s_cmp_eq_u32 s68, 0
    s_cselect_b32 s67, s67, -1
    s_cmp_eq_u32 s66, 2
    s_cselect_b32 s67, 8, s67
    s_mul_i32 s68, s65, 9
    s_add_u32 s68, s68, s67
    s_cmp_eq_u32 s67, -1
    s_cselect_b32 s67, -1, s68
    s_lshl_b32 s65, s65, 5
    s_add_u32 s65, s65, s66
    s_lshr_b32 s66, s65, 3
    v_lshlrev_b32 v5, 13, v3
    v_lshl_add_u32 v5, v4, 4, v5
    v_lshlrev_b32 v7, 1, v3
    v_lshlrev_b32 v8, 1, v2
    v_lshrrev_b32 v14, 3, v2
    v_lshlrev_b32 v6, 1, v14
    v_and_b32 v9, 7, v2
    v_mul_u32_u24 v13, 1152, v14
    v_lshl_add_u32 v13, v9, 4, v13
    v_add_u32 v13, 1024, v13
    v_mul_u32_u24 v14, 9216, v14
    v_lshl_add_u32 v14, v9, 4, v14
    v_and_b32 v9, 1, v3
    v_lshlrev_b32 v9, 1, v9
    v_lshrrev_b32 v10, 1, v3
    v_or_b32 v15, v9, v10
    s_mul_i32 s68, s64, 36
    s_lshl_b32 s69, s68, 1
    s_lshl_b32 s70, s68, 13
    s_lshl_b32 s71, s66, 8
    s_add_u32 s70, s70, s71
    s_and_b32 s72, s64, 7
    s_mul_i32 s72, s72, 72
    s_lshl_b32 s76, s72, 1
    s_mul_i32 s71, s72, 9216
    s_lshl_b32 s72, s67, 7
    s_add_u32 s71, s71, s72
    s_and_b32 s72, s66, 3
    s_cmp_eq_u32 s72, 0
    s_cselect_b32 s72, 1, 0
    s_mul_i32 s74, s72, 11
    s_add_i32 s74, s74, 564
    s_mul_i32 s69, s72, -40
    s_add_i32 s69, s69, 208
    s_and_b32 s73, s65, 7
    s_mul_i32 s75, s73, s74
    s_mov_b32 s77, 0
    s_cmp_gt_u32 s73, 0
    s_addc_u32 s77, s77, 0
    s_cmp_gt_u32 s73, 4
    s_addc_u32 s77, s77, 0
    s_cmp_gt_u32 s73, 2
    s_cselect_b32 s78, s72, 0
    s_add_u32 s77, s77, s78
    s_mul_i32 s77, s77, s69
    s_sub_u32 s75, s75, s77
    s_cmp_eq_u32 s67, -1
    s_cselect_b32 s77, 0, s69
    s_sub_u32 s74, s74, s77
    s_lshr_b32 s77, s74, 4
    s_and_b32 s78, s74, 15
    s_mul_i32 s73, s64, s77
    s_min_u32 s72, s64, s78
    s_add_u32 s73, s73, s72
    s_cmp_lt_u32 s64, s78
    s_addc_u32 s74, s77, 0
    s_mov_b32 s79, s74
    s_add_u32 s75, s75, s73
    s_lshl_b32 s75, s75, 10
    s_lshl_b32 s72, s66, 22
    s_add_u32 s80, s72, s75
    s_add_u32 s81, s80, 4096
    s_add_u32 s82, s80, 8192
    s_add_u32 s83, s80, 12288
    s_add_u32 s84, s80, 16384
    s_add_u32 s85, s80, 20480
    s_cmp_lt_u32 20, s74
    s_cselect_b32 s85, s85, 2130706432
    s_add_u32 s86, s80, 21504
    s_cmp_lt_u32 21, s74
    s_cselect_b32 s86, s86, 2130706432
    s_add_u32 s87, s80, 22528
    s_cmp_lt_u32 22, s74
    s_cselect_b32 s87, s87, 2130706432
    s_add_u32 s88, s80, 23552
    s_cmp_lt_u32 23, s74
    s_cselect_b32 s88, s88, 2130706432
    s_add_u32 s89, s80, 24576
    s_cmp_lt_u32 24, s74
    s_cselect_b32 s89, s89, 2130706432
    s_add_u32 s90, s80, 25600
    s_cmp_lt_u32 25, s74
    s_cselect_b32 s90, s90, 2130706432
    s_add_u32 s91, s80, 26624
    s_cmp_lt_u32 26, s74
    s_cselect_b32 s91, s91, 2130706432
    s_add_u32 s92, s80, 27648
    s_cmp_lt_u32 27, s74
    s_cselect_b32 s92, s92, 2130706432
    s_add_u32 s93, s80, 28672
    s_cmp_lt_u32 28, s74
    s_cselect_b32 s93, s93, 2130706432
    s_add_u32 s94, s80, 29696
    s_cmp_lt_u32 29, s74
    s_cselect_b32 s94, s94, 2130706432
    s_add_u32 s95, s80, 30720
    s_cmp_lt_u32 30, s74
    s_cselect_b32 s95, s95, 2130706432
    s_add_u32 s96, s80, 31744
    s_cmp_lt_u32 31, s74
    s_cselect_b32 s96, s96, 2130706432
    s_add_u32 s97, s80, 32768
    s_cmp_lt_u32 32, s74
    s_cselect_b32 s97, s97, 2130706432
    s_add_u32 s98, s80, 33792
    s_cmp_lt_u32 33, s74
    s_cselect_b32 s98, s98, 2130706432
    s_add_u32 s99, s80, 34816
    s_cmp_lt_u32 34, s74
    s_cselect_b32 s99, s99, 2130706432
    s_add_u32 s100, s80, 35840
    s_cmp_lt_u32 35, s74
    s_cselect_b32 s100, s100, 2130706432
    s_mul_i32 s68, s64, 36
    s_lshl_b32 s69, s68, 1
    s_waitcnt lgkmcnt(0)
    s_mov_b32 s28, s4
    s_and_b32 s29, s5, 0xffff
    s_mov_b32 s30, 1152
    s_mov_b32 s31, 0x00020000
    s_mov_b32 s32, s6
    s_and_b32 s33, s7, 0xffff
    s_mov_b32 s34, 134217728
    s_mov_b32 s35, 0x00020000
    s_mov_b32 s36, s8
    s_and_b32 s37, s9, 0xffff
    s_mov_b32 s38, 134217728
    s_mov_b32 s39, 0x00020000
    s_mov_b32 s40, s10
    s_and_b32 s41, s11, 0xffff
    s_mov_b32 s42, 4718592
    s_mov_b32 s43, 0x00020000
    s_mov_b32 s44, s12
    s_and_b32 s45, s13, 0xffff
    s_mov_b32 s46, 4718592
    s_mov_b32 s47, 0x00020000
    s_cmp_lt_u32 s64, 8
    s_cselect_b32 s48, s16, s18
    s_cselect_b32 s49, s17, s19
    s_and_b32 s49, s49, 0xffff
    s_mov_b32 s50, 5308416
    s_mov_b32 s51, 0x00020000
    s_mov_b32 s56, s20
    s_and_b32 s57, s21, 0xffff
    s_mov_b32 s58, 5308416
    s_mov_b32 s59, 0x00020000
    s_mov_b32 s60, s26
    s_and_b32 s61, s27, 0xffff
    s_mov_b32 s62, 1181696
    s_mov_b32 s63, 0x00020000
    buffer_load_ushort v34, v8, s[28:31], 0 offen offset:0
    buffer_load_ushort v35, v8, s[28:31], 0 offen offset:128
    buffer_load_ushort v36, v8, s[28:31], 0 offen offset:256
    buffer_load_ushort v37, v8, s[28:31], 0 offen offset:384
    buffer_load_ushort v38, v8, s[28:31], 0 offen offset:512
    buffer_load_ushort v39, v8, s[28:31], 0 offen offset:640
    buffer_load_ushort v40, v8, s[28:31], 0 offen offset:768
    buffer_load_ushort v41, v8, s[28:31], 0 offen offset:896
    buffer_load_ushort v42, v8, s[28:31], 0 offen offset:1024
    buffer_load_ushort v16, v7, s[28:31], s69 offen offset:0
    buffer_load_ushort v17, v7, s[28:31], s69 offen offset:8
    buffer_load_ushort v18, v7, s[28:31], s69 offen offset:16
    buffer_load_ushort v19, v7, s[28:31], s69 offen offset:24
    buffer_load_ushort v20, v7, s[28:31], s69 offen offset:32
    buffer_load_ushort v21, v7, s[28:31], s69 offen offset:40
    buffer_load_ushort v22, v7, s[28:31], s69 offen offset:48
    buffer_load_ushort v23, v7, s[28:31], s69 offen offset:56
    buffer_load_ushort v24, v7, s[28:31], s69 offen offset:64
    buffer_load_ushort v25, v6, s[28:31], s76 offen offset:0
    buffer_load_ushort v26, v6, s[28:31], s76 offen offset:16
    buffer_load_ushort v27, v6, s[28:31], s76 offen offset:32
    buffer_load_ushort v28, v6, s[28:31], s76 offen offset:48
    buffer_load_ushort v29, v6, s[28:31], s76 offen offset:64
    buffer_load_ushort v30, v6, s[28:31], s76 offen offset:80
    buffer_load_ushort v31, v6, s[28:31], s76 offen offset:96
    buffer_load_ushort v32, v6, s[28:31], s76 offen offset:112
    buffer_load_ushort v33, v6, s[28:31], s76 offen offset:128
    buffer_load_dwordx4 v[52:55], v5, s[40:43], s70 offen
    s_add_u32 s70, s70, 32768
    buffer_load_dwordx4 v[56:59], v5, s[40:43], s70 offen
    s_add_u32 s70, s70, 32768
    buffer_load_dwordx4 v[60:63], v5, s[40:43], s70 offen
    s_add_u32 s70, s70, 32768
    buffer_load_dwordx4 v[64:67], v5, s[40:43], s70 offen
    s_add_u32 s70, s70, 32768
    buffer_load_dwordx4 v[68:71], v5, s[40:43], s70 offen
    s_add_u32 s70, s70, 32768
    buffer_load_dwordx4 v[72:75], v5, s[40:43], s70 offen
    s_add_u32 s70, s70, 32768
    buffer_load_dwordx4 v[76:79], v5, s[40:43], s70 offen
    s_add_u32 s70, s70, 32768
    buffer_load_dwordx4 v[80:83], v5, s[40:43], s70 offen
    s_add_u32 s70, s70, 32768
    buffer_load_dwordx4 v[84:87], v5, s[40:43], s70 offen
    buffer_load_dwordx4 v[88:91], v1, s[32:35], s80 offen offset:0 nt
    buffer_load_dwordx4 v[92:95], v1, s[32:35], s80 offen offset:1024 nt
    buffer_load_dwordx4 v[96:99], v1, s[32:35], s80 offen offset:2048 nt
    buffer_load_dwordx4 v[100:103], v1, s[32:35], s80 offen offset:3072 nt
    buffer_load_dwordx4 v[104:107], v1, s[32:35], s81 offen offset:0 nt
    buffer_load_dwordx4 v[108:111], v1, s[32:35], s81 offen offset:1024 nt
    buffer_load_dwordx4 v[112:115], v1, s[32:35], s81 offen offset:2048 nt
    s_waitcnt vmcnt(34)
    v_lshlrev_b32 v34, 16, v34
    v_lshlrev_b32 v35, 16, v35
    v_lshlrev_b32 v36, 16, v36
    v_lshlrev_b32 v37, 16, v37
    v_lshlrev_b32 v38, 16, v38
    v_lshlrev_b32 v39, 16, v39
    v_lshlrev_b32 v40, 16, v40
    v_lshlrev_b32 v41, 16, v41
    v_lshlrev_b32 v42, 16, v42
    v_add_f32 v9, v34, v35
    v_add_f32 v9, v9, v36
    v_add_f32 v9, v9, v37
    v_add_f32 v9, v9, v38
    v_add_f32 v9, v9, v39
    v_add_f32 v9, v9, v40
    v_add_f32 v9, v9, v41
    v_add_f32 v9, v9, v42
    s_nop 1
    v_add_f32_dpp v9, v9, v9 row_ror:8 row_mask:0xf bank_mask:0xf
    s_nop 1
    v_add_f32_dpp v9, v9, v9 row_ror:4 row_mask:0xf bank_mask:0xf
    s_nop 1
    v_add_f32_dpp v9, v9, v9 row_ror:2 row_mask:0xf bank_mask:0xf
    s_nop 1
    v_add_f32_dpp v9, v9, v9 row_ror:1 row_mask:0xf bank_mask:0xf
    v_mov_b32 v10, v9
    s_nop 1
    v_permlane32_swap_b32 v9, v10
    v_add_f32 v9, v9, v10
    v_mov_b32 v10, v9
    s_nop 1
    v_permlane16_swap_b32 v9, v10
    v_add_f32 v9, v9, v10
    v_mul_f32 v9, 0x3ae38e39, v9
    v_sub_f32 v11, v34, v9
    v_mul_f32 v10, v11, v11
    v_sub_f32 v11, v35, v9
    v_fmac_f32 v10, v11, v11
    v_sub_f32 v11, v36, v9
    v_fmac_f32 v10, v11, v11
    v_sub_f32 v11, v37, v9
    v_fmac_f32 v10, v11, v11
    v_sub_f32 v11, v38, v9
    v_fmac_f32 v10, v11, v11
    v_sub_f32 v11, v39, v9
    v_fmac_f32 v10, v11, v11
    v_sub_f32 v11, v40, v9
    v_fmac_f32 v10, v11, v11
    v_sub_f32 v11, v41, v9
    v_fmac_f32 v10, v11, v11
    v_sub_f32 v11, v42, v9
    v_fmac_f32 v10, v11, v11
    s_nop 1
    v_add_f32_dpp v10, v10, v10 row_ror:8 row_mask:0xf bank_mask:0xf
    s_nop 1
    v_add_f32_dpp v10, v10, v10 row_ror:4 row_mask:0xf bank_mask:0xf
    s_nop 1
    v_add_f32_dpp v10, v10, v10 row_ror:2 row_mask:0xf bank_mask:0xf
    s_nop 1
    v_add_f32_dpp v10, v10, v10 row_ror:1 row_mask:0xf bank_mask:0xf
    v_mov_b32 v11, v10
    s_nop 1
    v_permlane32_swap_b32 v10, v11
    v_add_f32 v10, v10, v11
    v_mov_b32 v11, v10
    s_nop 1
    v_permlane16_swap_b32 v10, v11
    v_add_f32 v10, v10, v11
    v_mul_f32 v10, 0x3ae38e39, v10
    v_cvt_pk_bf16_f32 v9, v9, v9
    v_lshlrev_b32 v9, 16, v9
    v_cvt_pk_bf16_f32 v10, v10, v10
    v_lshlrev_b32 v10, 16, v10
    v_add_f32 v10, 0x3727c5ac, v10
    v_cvt_pk_bf16_f32 v10, v10, v10
    v_lshlrev_b32 v10, 16, v10
    v_sqrt_f32 v10, v10
    s_nop 0
    v_cvt_pk_bf16_f32 v10, v10, v10
    v_lshlrev_b32 v10, 16, v10
    v_rcp_f32 v11, v10
    s_waitcnt vmcnt(16)
    v_lshlrev_b32 v16, 16, v16
    v_sub_f32 v16, v16, v9
    v_cvt_pk_bf16_f32 v16, v16, v16
    v_lshlrev_b32 v16, 16, v16
    v_mul_f32 v12, v16, v11
    v_fma_f32 v6, -v12, v10, v16
    v_fma_f32 v16, v6, v11, v12
    v_cvt_pk_bf16_f32 v16, v16, v16
    v_lshlrev_b32 v16, 16, v16
    v_lshlrev_b32 v17, 16, v17
    v_sub_f32 v17, v17, v9
    v_cvt_pk_bf16_f32 v17, v17, v17
    v_lshlrev_b32 v17, 16, v17
    v_mul_f32 v12, v17, v11
    v_fma_f32 v6, -v12, v10, v17
    v_fma_f32 v17, v6, v11, v12
    v_cvt_pk_bf16_f32 v17, v17, v17
    v_lshlrev_b32 v17, 16, v17
    v_lshlrev_b32 v18, 16, v18
    v_sub_f32 v18, v18, v9
    v_cvt_pk_bf16_f32 v18, v18, v18
    v_lshlrev_b32 v18, 16, v18
    v_mul_f32 v12, v18, v11
    v_fma_f32 v6, -v12, v10, v18
    v_fma_f32 v18, v6, v11, v12
    v_cvt_pk_bf16_f32 v18, v18, v18
    v_lshlrev_b32 v18, 16, v18
    v_lshlrev_b32 v19, 16, v19
    v_sub_f32 v19, v19, v9
    v_cvt_pk_bf16_f32 v19, v19, v19
    v_lshlrev_b32 v19, 16, v19
    v_mul_f32 v12, v19, v11
    v_fma_f32 v6, -v12, v10, v19
    v_fma_f32 v19, v6, v11, v12
    v_cvt_pk_bf16_f32 v19, v19, v19
    v_lshlrev_b32 v19, 16, v19
    v_lshlrev_b32 v20, 16, v20
    v_sub_f32 v20, v20, v9
    v_cvt_pk_bf16_f32 v20, v20, v20
    v_lshlrev_b32 v20, 16, v20
    v_mul_f32 v12, v20, v11
    v_fma_f32 v6, -v12, v10, v20
    v_fma_f32 v20, v6, v11, v12
    v_cvt_pk_bf16_f32 v20, v20, v20
    v_lshlrev_b32 v20, 16, v20
    v_lshlrev_b32 v21, 16, v21
    v_sub_f32 v21, v21, v9
    v_cvt_pk_bf16_f32 v21, v21, v21
    v_lshlrev_b32 v21, 16, v21
    v_mul_f32 v12, v21, v11
    v_fma_f32 v6, -v12, v10, v21
    v_fma_f32 v21, v6, v11, v12
    v_cvt_pk_bf16_f32 v21, v21, v21
    v_lshlrev_b32 v21, 16, v21
    v_lshlrev_b32 v22, 16, v22
    v_sub_f32 v22, v22, v9
    v_cvt_pk_bf16_f32 v22, v22, v22
    v_lshlrev_b32 v22, 16, v22
    v_mul_f32 v12, v22, v11
    v_fma_f32 v6, -v12, v10, v22
    v_fma_f32 v22, v6, v11, v12
    v_cvt_pk_bf16_f32 v22, v22, v22
    v_lshlrev_b32 v22, 16, v22
    v_lshlrev_b32 v23, 16, v23
    v_sub_f32 v23, v23, v9
    v_cvt_pk_bf16_f32 v23, v23, v23
    v_lshlrev_b32 v23, 16, v23
    v_mul_f32 v12, v23, v11
    v_fma_f32 v6, -v12, v10, v23
    v_fma_f32 v23, v6, v11, v12
    v_cvt_pk_bf16_f32 v23, v23, v23
    v_lshlrev_b32 v23, 16, v23
    v_lshlrev_b32 v24, 16, v24
    v_sub_f32 v24, v24, v9
    v_cvt_pk_bf16_f32 v24, v24, v24
    v_lshlrev_b32 v24, 16, v24
    v_mul_f32 v12, v24, v11
    v_fma_f32 v6, -v12, v10, v24
    v_fma_f32 v24, v6, v11, v12
    v_cvt_pk_bf16_f32 v24, v24, v24
    v_lshlrev_b32 v24, 16, v24
    v_lshlrev_b32 v25, 16, v25
    v_sub_f32 v25, v25, v9
    v_cvt_pk_bf16_f32 v25, v25, v25
    v_lshlrev_b32 v25, 16, v25
    v_mul_f32 v12, v25, v11
    v_fma_f32 v6, -v12, v10, v25
    v_fma_f32 v25, v6, v11, v12
    v_cvt_pk_bf16_f32 v25, v25, v25
    v_lshlrev_b32 v25, 16, v25
    v_lshlrev_b32 v26, 16, v26
    v_sub_f32 v26, v26, v9
    v_cvt_pk_bf16_f32 v26, v26, v26
    v_lshlrev_b32 v26, 16, v26
    v_mul_f32 v12, v26, v11
    v_fma_f32 v6, -v12, v10, v26
    v_fma_f32 v26, v6, v11, v12
    v_cvt_pk_bf16_f32 v26, v26, v26
    v_lshlrev_b32 v26, 16, v26
    v_lshlrev_b32 v27, 16, v27
    v_sub_f32 v27, v27, v9
    v_cvt_pk_bf16_f32 v27, v27, v27
    v_lshlrev_b32 v27, 16, v27
    v_mul_f32 v12, v27, v11
    v_fma_f32 v6, -v12, v10, v27
    v_fma_f32 v27, v6, v11, v12
    v_cvt_pk_bf16_f32 v27, v27, v27
    v_lshlrev_b32 v27, 16, v27
    v_lshlrev_b32 v28, 16, v28
    v_sub_f32 v28, v28, v9
    v_cvt_pk_bf16_f32 v28, v28, v28
    v_lshlrev_b32 v28, 16, v28
    v_mul_f32 v12, v28, v11
    v_fma_f32 v6, -v12, v10, v28
    v_fma_f32 v28, v6, v11, v12
    v_cvt_pk_bf16_f32 v28, v28, v28
    v_lshlrev_b32 v28, 16, v28
    v_lshlrev_b32 v29, 16, v29
    v_sub_f32 v29, v29, v9
    v_cvt_pk_bf16_f32 v29, v29, v29
    v_lshlrev_b32 v29, 16, v29
    v_mul_f32 v12, v29, v11
    v_fma_f32 v6, -v12, v10, v29
    v_fma_f32 v29, v6, v11, v12
    v_cvt_pk_bf16_f32 v29, v29, v29
    v_lshlrev_b32 v29, 16, v29
    v_lshlrev_b32 v30, 16, v30
    v_sub_f32 v30, v30, v9
    v_cvt_pk_bf16_f32 v30, v30, v30
    v_lshlrev_b32 v30, 16, v30
    v_mul_f32 v12, v30, v11
    v_fma_f32 v6, -v12, v10, v30
    v_fma_f32 v30, v6, v11, v12
    v_cvt_pk_bf16_f32 v30, v30, v30
    v_lshlrev_b32 v30, 16, v30
    v_lshlrev_b32 v31, 16, v31
    v_sub_f32 v31, v31, v9
    v_cvt_pk_bf16_f32 v31, v31, v31
    v_lshlrev_b32 v31, 16, v31
    v_mul_f32 v12, v31, v11
    v_fma_f32 v6, -v12, v10, v31
    v_fma_f32 v31, v6, v11, v12
    v_cvt_pk_bf16_f32 v31, v31, v31
    v_lshlrev_b32 v31, 16, v31
    v_lshlrev_b32 v32, 16, v32
    v_sub_f32 v32, v32, v9
    v_cvt_pk_bf16_f32 v32, v32, v32
    v_lshlrev_b32 v32, 16, v32
    v_mul_f32 v12, v32, v11
    v_fma_f32 v6, -v12, v10, v32
    v_fma_f32 v32, v6, v11, v12
    v_cvt_pk_bf16_f32 v32, v32, v32
    v_lshlrev_b32 v32, 16, v32
    v_lshlrev_b32 v33, 16, v33
    v_sub_f32 v33, v33, v9
    v_cvt_pk_bf16_f32 v33, v33, v33
    v_lshlrev_b32 v33, 16, v33
    v_mul_f32 v12, v33, v11
    v_fma_f32 v6, -v12, v10, v33
    v_fma_f32 v33, v6, v11, v12
    v_cvt_pk_bf16_f32 v33, v33, v33
    v_lshlrev_b32 v33, 16, v33
    s_waitcnt vmcnt(15)
    v_lshlrev_b32 v5, 16, v52
    v_and_b32 v6, 0xffff0000, v52
    v_lshlrev_b32 v7, 16, v53
    v_and_b32 v8, 0xffff0000, v53
    v_lshlrev_b32 v9, 16, v54
    v_and_b32 v10, 0xffff0000, v54
    v_lshlrev_b32 v11, 16, v55
    v_and_b32 v12, 0xffff0000, v55
    v_mul_f32 v116, v16, v5
    v_mul_f32 v117, v16, v6
    v_mul_f32 v118, v16, v7
    v_mul_f32 v119, v16, v8
    v_mul_f32 v120, v16, v9
    v_mul_f32 v121, v16, v10
    v_mul_f32 v122, v16, v11
    v_mul_f32 v123, v16, v12
    s_waitcnt vmcnt(14)
    v_lshlrev_b32 v5, 16, v56
    v_and_b32 v6, 0xffff0000, v56
    v_lshlrev_b32 v7, 16, v57
    v_and_b32 v8, 0xffff0000, v57
    v_lshlrev_b32 v9, 16, v58
    v_and_b32 v10, 0xffff0000, v58
    v_lshlrev_b32 v11, 16, v59
    v_and_b32 v12, 0xffff0000, v59
    v_fmac_f32 v116, v17, v5
    v_fmac_f32 v117, v17, v6
    v_fmac_f32 v118, v17, v7
    v_fmac_f32 v119, v17, v8
    v_fmac_f32 v120, v17, v9
    v_fmac_f32 v121, v17, v10
    v_fmac_f32 v122, v17, v11
    v_fmac_f32 v123, v17, v12
    s_waitcnt vmcnt(13)
    v_lshlrev_b32 v5, 16, v60
    v_and_b32 v6, 0xffff0000, v60
    v_lshlrev_b32 v7, 16, v61
    v_and_b32 v8, 0xffff0000, v61
    v_lshlrev_b32 v9, 16, v62
    v_and_b32 v10, 0xffff0000, v62
    v_lshlrev_b32 v11, 16, v63
    v_and_b32 v12, 0xffff0000, v63
    v_fmac_f32 v116, v18, v5
    v_fmac_f32 v117, v18, v6
    v_fmac_f32 v118, v18, v7
    v_fmac_f32 v119, v18, v8
    v_fmac_f32 v120, v18, v9
    v_fmac_f32 v121, v18, v10
    v_fmac_f32 v122, v18, v11
    v_fmac_f32 v123, v18, v12
    s_waitcnt vmcnt(12)
    v_lshlrev_b32 v5, 16, v64
    v_and_b32 v6, 0xffff0000, v64
    v_lshlrev_b32 v7, 16, v65
    v_and_b32 v8, 0xffff0000, v65
    v_lshlrev_b32 v9, 16, v66
    v_and_b32 v10, 0xffff0000, v66
    v_lshlrev_b32 v11, 16, v67
    v_and_b32 v12, 0xffff0000, v67
    v_fmac_f32 v116, v19, v5
    v_fmac_f32 v117, v19, v6
    v_fmac_f32 v118, v19, v7
    v_fmac_f32 v119, v19, v8
    v_fmac_f32 v120, v19, v9
    v_fmac_f32 v121, v19, v10
    v_fmac_f32 v122, v19, v11
    v_fmac_f32 v123, v19, v12
    s_waitcnt vmcnt(11)
    v_lshlrev_b32 v5, 16, v68
    v_and_b32 v6, 0xffff0000, v68
    v_lshlrev_b32 v7, 16, v69
    v_and_b32 v8, 0xffff0000, v69
    v_lshlrev_b32 v9, 16, v70
    v_and_b32 v10, 0xffff0000, v70
    v_lshlrev_b32 v11, 16, v71
    v_and_b32 v12, 0xffff0000, v71
    v_fmac_f32 v116, v20, v5
    v_fmac_f32 v117, v20, v6
    v_fmac_f32 v118, v20, v7
    v_fmac_f32 v119, v20, v8
    v_fmac_f32 v120, v20, v9
    v_fmac_f32 v121, v20, v10
    v_fmac_f32 v122, v20, v11
    v_fmac_f32 v123, v20, v12
    s_waitcnt vmcnt(10)
    v_lshlrev_b32 v5, 16, v72
    v_and_b32 v6, 0xffff0000, v72
    v_lshlrev_b32 v7, 16, v73
    v_and_b32 v8, 0xffff0000, v73
    v_lshlrev_b32 v9, 16, v74
    v_and_b32 v10, 0xffff0000, v74
    v_lshlrev_b32 v11, 16, v75
    v_and_b32 v12, 0xffff0000, v75
    v_fmac_f32 v116, v21, v5
    v_fmac_f32 v117, v21, v6
    v_fmac_f32 v118, v21, v7
    v_fmac_f32 v119, v21, v8
    v_fmac_f32 v120, v21, v9
    v_fmac_f32 v121, v21, v10
    v_fmac_f32 v122, v21, v11
    v_fmac_f32 v123, v21, v12
    s_waitcnt vmcnt(9)
    v_lshlrev_b32 v5, 16, v76
    v_and_b32 v6, 0xffff0000, v76
    v_lshlrev_b32 v7, 16, v77
    v_and_b32 v8, 0xffff0000, v77
    v_lshlrev_b32 v9, 16, v78
    v_and_b32 v10, 0xffff0000, v78
    v_lshlrev_b32 v11, 16, v79
    v_and_b32 v12, 0xffff0000, v79
    v_fmac_f32 v116, v22, v5
    v_fmac_f32 v117, v22, v6
    v_fmac_f32 v118, v22, v7
    v_fmac_f32 v119, v22, v8
    v_fmac_f32 v120, v22, v9
    v_fmac_f32 v121, v22, v10
    v_fmac_f32 v122, v22, v11
    v_fmac_f32 v123, v22, v12
    s_waitcnt vmcnt(8)
    v_lshlrev_b32 v5, 16, v80
    v_and_b32 v6, 0xffff0000, v80
    v_lshlrev_b32 v7, 16, v81
    v_and_b32 v8, 0xffff0000, v81
    v_lshlrev_b32 v9, 16, v82
    v_and_b32 v10, 0xffff0000, v82
    v_lshlrev_b32 v11, 16, v83
    v_and_b32 v12, 0xffff0000, v83
    v_fmac_f32 v116, v23, v5
    v_fmac_f32 v117, v23, v6
    v_fmac_f32 v118, v23, v7
    v_fmac_f32 v119, v23, v8
    v_fmac_f32 v120, v23, v9
    v_fmac_f32 v121, v23, v10
    v_fmac_f32 v122, v23, v11
    v_fmac_f32 v123, v23, v12
    s_waitcnt vmcnt(7)
    v_lshlrev_b32 v5, 16, v84
    v_and_b32 v6, 0xffff0000, v84
    v_lshlrev_b32 v7, 16, v85
    v_and_b32 v8, 0xffff0000, v85
    v_lshlrev_b32 v9, 16, v86
    v_and_b32 v10, 0xffff0000, v86
    v_lshlrev_b32 v11, 16, v87
    v_and_b32 v12, 0xffff0000, v87
    v_fmac_f32 v116, v24, v5
    v_fmac_f32 v117, v24, v6
    v_fmac_f32 v118, v24, v7
    v_fmac_f32 v119, v24, v8
    v_fmac_f32 v120, v24, v9
    v_fmac_f32 v121, v24, v10
    v_fmac_f32 v122, v24, v11
    v_fmac_f32 v123, v24, v12
    v_permlane32_swap_b32 v116, v117
    v_permlane32_swap_b32 v118, v119
    v_add_f32 v116, v116, v117
    v_add_f32 v118, v118, v119
    s_nop 1
    v_permlane16_swap_b32 v116, v118
    v_add_f32 v116, v116, v118
    v_permlane32_swap_b32 v120, v121
    v_permlane32_swap_b32 v122, v123
    v_add_f32 v120, v120, v121
    v_add_f32 v122, v122, v123
    s_nop 1
    v_permlane16_swap_b32 v120, v122
    v_add_f32 v120, v120, v122
    v_lshl_add_u32 v5, v4, 3, v15
    v_lshlrev_b32 v5, 2, v5
    s_lshl_b32 s73, s64, 9
    v_add_u32 v5, s73, v5
    ds_write_b32 v5, v116 offset:0
    ds_write_b32 v5, v120 offset:16
    s_cmp_eq_u32 s67, -1
    s_cbranch_scc1 L_k1_noffn1
    buffer_load_dwordx4 v[52:55], v14, s[48:51], s71 offen nt
    s_add_u32 s71, s71, 73728
    buffer_load_dwordx4 v[56:59], v14, s[48:51], s71 offen nt
    s_add_u32 s71, s71, 73728
    buffer_load_dwordx4 v[60:63], v14, s[48:51], s71 offen nt
    s_add_u32 s71, s71, 73728
    buffer_load_dwordx4 v[64:67], v14, s[48:51], s71 offen nt
    s_add_u32 s71, s71, 73728
    buffer_load_dwordx4 v[68:71], v14, s[48:51], s71 offen nt
    s_add_u32 s71, s71, 73728
    buffer_load_dwordx4 v[72:75], v14, s[48:51], s71 offen nt
    s_add_u32 s71, s71, 73728
    buffer_load_dwordx4 v[76:79], v14, s[48:51], s71 offen nt
    s_add_u32 s71, s71, 73728
    buffer_load_dwordx4 v[80:83], v14, s[48:51], s71 offen nt
    s_add_u32 s71, s71, 73728
    buffer_load_dwordx4 v[84:87], v14, s[48:51], s71 offen nt
    s_waitcnt vmcnt(8)
    v_lshlrev_b32 v5, 16, v52
    v_and_b32 v6, 0xffff0000, v52
    v_lshlrev_b32 v7, 16, v53
    v_and_b32 v8, 0xffff0000, v53
    v_lshlrev_b32 v9, 16, v54
    v_and_b32 v10, 0xffff0000, v54
    v_lshlrev_b32 v11, 16, v55
    v_and_b32 v12, 0xffff0000, v55
    v_mul_f32 v16, v25, v5
    v_mul_f32 v17, v25, v6
    v_mul_f32 v18, v25, v7
    v_mul_f32 v19, v25, v8
    v_mul_f32 v20, v25, v9
    v_mul_f32 v21, v25, v10
    v_mul_f32 v22, v25, v11
    v_mul_f32 v23, v25, v12
    s_waitcnt vmcnt(7)
    v_lshlrev_b32 v5, 16, v56
    v_and_b32 v6, 0xffff0000, v56
    v_lshlrev_b32 v7, 16, v57
    v_and_b32 v8, 0xffff0000, v57
    v_lshlrev_b32 v9, 16, v58
    v_and_b32 v10, 0xffff0000, v58
    v_lshlrev_b32 v11, 16, v59
    v_and_b32 v12, 0xffff0000, v59
    v_fmac_f32 v16, v26, v5
    v_fmac_f32 v17, v26, v6
    v_fmac_f32 v18, v26, v7
    v_fmac_f32 v19, v26, v8
    v_fmac_f32 v20, v26, v9
    v_fmac_f32 v21, v26, v10
    v_fmac_f32 v22, v26, v11
    v_fmac_f32 v23, v26, v12
    s_waitcnt vmcnt(6)
    v_lshlrev_b32 v5, 16, v60
    v_and_b32 v6, 0xffff0000, v60
    v_lshlrev_b32 v7, 16, v61
    v_and_b32 v8, 0xffff0000, v61
    v_lshlrev_b32 v9, 16, v62
    v_and_b32 v10, 0xffff0000, v62
    v_lshlrev_b32 v11, 16, v63
    v_and_b32 v12, 0xffff0000, v63
    v_fmac_f32 v16, v27, v5
    v_fmac_f32 v17, v27, v6
    v_fmac_f32 v18, v27, v7
    v_fmac_f32 v19, v27, v8
    v_fmac_f32 v20, v27, v9
    v_fmac_f32 v21, v27, v10
    v_fmac_f32 v22, v27, v11
    v_fmac_f32 v23, v27, v12
    s_waitcnt vmcnt(5)
    v_lshlrev_b32 v5, 16, v64
    v_and_b32 v6, 0xffff0000, v64
    v_lshlrev_b32 v7, 16, v65
    v_and_b32 v8, 0xffff0000, v65
    v_lshlrev_b32 v9, 16, v66
    v_and_b32 v10, 0xffff0000, v66
    v_lshlrev_b32 v11, 16, v67
    v_and_b32 v12, 0xffff0000, v67
    v_fmac_f32 v16, v28, v5
    v_fmac_f32 v17, v28, v6
    v_fmac_f32 v18, v28, v7
    v_fmac_f32 v19, v28, v8
    v_fmac_f32 v20, v28, v9
    v_fmac_f32 v21, v28, v10
    v_fmac_f32 v22, v28, v11
    v_fmac_f32 v23, v28, v12
    s_waitcnt vmcnt(4)
    v_lshlrev_b32 v5, 16, v68
    v_and_b32 v6, 0xffff0000, v68
    v_lshlrev_b32 v7, 16, v69
    v_and_b32 v8, 0xffff0000, v69
    v_lshlrev_b32 v9, 16, v70
    v_and_b32 v10, 0xffff0000, v70
    v_lshlrev_b32 v11, 16, v71
    v_and_b32 v12, 0xffff0000, v71
    v_fmac_f32 v16, v29, v5
    v_fmac_f32 v17, v29, v6
    v_fmac_f32 v18, v29, v7
    v_fmac_f32 v19, v29, v8
    v_fmac_f32 v20, v29, v9
    v_fmac_f32 v21, v29, v10
    v_fmac_f32 v22, v29, v11
    v_fmac_f32 v23, v29, v12
    s_waitcnt vmcnt(3)
    v_lshlrev_b32 v5, 16, v72
    v_and_b32 v6, 0xffff0000, v72
    v_lshlrev_b32 v7, 16, v73
    v_and_b32 v8, 0xffff0000, v73
    v_lshlrev_b32 v9, 16, v74
    v_and_b32 v10, 0xffff0000, v74
    v_lshlrev_b32 v11, 16, v75
    v_and_b32 v12, 0xffff0000, v75
    v_fmac_f32 v16, v30, v5
    v_fmac_f32 v17, v30, v6
    v_fmac_f32 v18, v30, v7
    v_fmac_f32 v19, v30, v8
    v_fmac_f32 v20, v30, v9
    v_fmac_f32 v21, v30, v10
    v_fmac_f32 v22, v30, v11
    v_fmac_f32 v23, v30, v12
    s_waitcnt vmcnt(2)
    v_lshlrev_b32 v5, 16, v76
    v_and_b32 v6, 0xffff0000, v76
    v_lshlrev_b32 v7, 16, v77
    v_and_b32 v8, 0xffff0000, v77
    v_lshlrev_b32 v9, 16, v78
    v_and_b32 v10, 0xffff0000, v78
    v_lshlrev_b32 v11, 16, v79
    v_and_b32 v12, 0xffff0000, v79
    v_fmac_f32 v16, v31, v5
    v_fmac_f32 v17, v31, v6
    v_fmac_f32 v18, v31, v7
    v_fmac_f32 v19, v31, v8
    v_fmac_f32 v20, v31, v9
    v_fmac_f32 v21, v31, v10
    v_fmac_f32 v22, v31, v11
    v_fmac_f32 v23, v31, v12
    s_waitcnt vmcnt(1)
    v_lshlrev_b32 v5, 16, v80
    v_and_b32 v6, 0xffff0000, v80
    v_lshlrev_b32 v7, 16, v81
    v_and_b32 v8, 0xffff0000, v81
    v_lshlrev_b32 v9, 16, v82
    v_and_b32 v10, 0xffff0000, v82
    v_lshlrev_b32 v11, 16, v83
    v_and_b32 v12, 0xffff0000, v83
    v_fmac_f32 v16, v32, v5
    v_fmac_f32 v17, v32, v6
    v_fmac_f32 v18, v32, v7
    v_fmac_f32 v19, v32, v8
    v_fmac_f32 v20, v32, v9
    v_fmac_f32 v21, v32, v10
    v_fmac_f32 v22, v32, v11
    v_fmac_f32 v23, v32, v12
    s_waitcnt vmcnt(0)
    v_lshlrev_b32 v5, 16, v84
    v_and_b32 v6, 0xffff0000, v84
    v_lshlrev_b32 v7, 16, v85
    v_and_b32 v8, 0xffff0000, v85
    v_lshlrev_b32 v9, 16, v86
    v_and_b32 v10, 0xffff0000, v86
    v_lshlrev_b32 v11, 16, v87
    v_and_b32 v12, 0xffff0000, v87
    v_fmac_f32 v16, v33, v5
    v_fmac_f32 v17, v33, v6
    v_fmac_f32 v18, v33, v7
    v_fmac_f32 v19, v33, v8
    v_fmac_f32 v20, v33, v9
    v_fmac_f32 v21, v33, v10
    v_fmac_f32 v22, v33, v11
    v_fmac_f32 v23, v33, v12
    v_permlane32_swap_b32 v16, v17
    v_permlane32_swap_b32 v18, v19
    v_add_f32 v16, v16, v17
    v_add_f32 v18, v18, v19
    s_nop 1
    v_permlane16_swap_b32 v16, v18
    v_add_f32 v16, v16, v18
    v_permlane32_swap_b32 v20, v21
    v_permlane32_swap_b32 v22, v23
    v_add_f32 v20, v20, v21
    v_add_f32 v22, v22, v23
    s_nop 1
    v_permlane16_swap_b32 v20, v22
    v_add_f32 v20, v20, v22
    v_add_f32_dpp v16, v16, v16 row_ror:8 row_mask:0xf bank_mask:0xf
    s_nop 0
    v_add_f32_dpp v20, v20, v20 row_ror:8 row_mask:0xf bank_mask:0xf
    v_and_b32 v5, 7, v4
    v_lshl_add_u32 v5, v5, 3, v15
    v_lshlrev_b32 v5, 2, v5
    s_lshl_b32 s73, s64, 8
    v_add_u32 v5, s73, v5
    ds_write_b32 v5, v16 offset:8192
    ds_write_b32 v5, v20 offset:8208
L_k1_noffn1:
    s_nop 4
    buffer_load_dwordx4 v[52:55], v1, s[32:35], s81 offen offset:3072 nt
    buffer_load_dwordx4 v[56:59], v1, s[32:35], s82 offen offset:0 nt
    buffer_load_dwordx4 v[60:63], v1, s[32:35], s82 offen offset:1024 nt
    buffer_load_dwordx4 v[64:67], v1, s[32:35], s82 offen offset:2048 nt
    buffer_load_dwordx4 v[68:71], v1, s[32:35], s82 offen offset:3072 nt
    buffer_load_dwordx4 v[72:75], v1, s[32:35], s83 offen offset:0 nt
    buffer_load_dwordx4 v[76:79], v1, s[32:35], s83 offen offset:1024 nt
    buffer_load_dwordx4 v[80:83], v1, s[32:35], s83 offen offset:2048 nt
    buffer_load_dwordx4 v[84:87], v1, s[32:35], s83 offen offset:3072 nt
    s_lshl_b32 s72, s67, 6
    s_lshl_b32 s73, s64, 2
    s_add_u32 s72, s72, s73
    s_mul_i32 s72, s72, 1152
    s_cmp_eq_u32 s67, -1
    s_cselect_b32 s72, 2130706432, s72
    buffer_load_dwordx4 v[28:31], v1, s[56:59], s72 offen offset:0 nt
    buffer_load_dwordx4 v[32:35], v1, s[56:59], s72 offen offset:1152 nt
    buffer_load_dwordx4 v[36:39], v1, s[56:59], s72 offen offset:2304 nt
    buffer_load_dwordx4 v[40:43], v1, s[56:59], s72 offen offset:3456 nt
    buffer_load_dwordx4 v[44:47], v13, s[56:59], s72 offen nt
    s_waitcnt lgkmcnt(0)
    s_barrier
    s_cmp_ge_u32 s64, 3
    s_cbranch_scc1 L_k1_s2done
    s_cmp_eq_u32 s64, 2
    s_cbranch_scc1 L_k1_s2ffn
    v_lshlrev_b32 v5, 2, v0
    ds_read_b32 v116, v5 offset:0
    ds_read_b32 v117, v5 offset:512
    ds_read_b32 v118, v5 offset:1024
    ds_read_b32 v119, v5 offset:1536
    ds_read_b32 v120, v5 offset:2048
    ds_read_b32 v121, v5 offset:2560
    ds_read_b32 v122, v5 offset:3072
    ds_read_b32 v123, v5 offset:3584
    ds_read_b32 v16, v5 offset:4096
    ds_read_b32 v17, v5 offset:4608
    ds_read_b32 v18, v5 offset:5120
    ds_read_b32 v19, v5 offset:5632
    ds_read_b32 v20, v5 offset:6144
    ds_read_b32 v21, v5 offset:6656
    ds_read_b32 v22, v5 offset:7168
    ds_read_b32 v23, v5 offset:7680
    s_waitcnt lgkmcnt(0)
    v_add_f32 v116, v116, v117
    v_add_f32 v116, v116, v118
    v_add_f32 v116, v116, v119
    v_add_f32 v116, v116, v120
    v_add_f32 v116, v116, v121
    v_add_f32 v116, v116, v122
    v_add_f32 v116, v116, v123
    v_add_f32 v116, v116, v16
    v_add_f32 v116, v116, v17
    v_add_f32 v116, v116, v18
    v_add_f32 v116, v116, v19
    v_add_f32 v116, v116, v20
    v_add_f32 v116, v116, v21
    v_add_f32 v116, v116, v22
    v_add_f32 v116, v116, v23
    v_cvt_pk_bf16_f32 v6, v116, v116
    v_lshlrev_b32 v5, 1, v0
    ds_write_b16 v5, v6 offset:12288
    s_branch L_k1_s2done
L_k1_s2ffn:
    s_nop 4
    v_lshlrev_b32 v5, 2, v2
    ds_read_b32 v116, v5 offset:8192
    ds_read_b32 v117, v5 offset:8448
    ds_read_b32 v118, v5 offset:8704
    ds_read_b32 v119, v5 offset:8960
    ds_read_b32 v120, v5 offset:9216
    ds_read_b32 v121, v5 offset:9472
    ds_read_b32 v122, v5 offset:9728
    ds_read_b32 v123, v5 offset:9984
    ds_read_b32 v16, v5 offset:10240
    ds_read_b32 v17, v5 offset:10496
    ds_read_b32 v18, v5 offset:10752
    ds_read_b32 v19, v5 offset:11008
    ds_read_b32 v20, v5 offset:11264
    ds_read_b32 v21, v5 offset:11520
    ds_read_b32 v22, v5 offset:11776
    ds_read_b32 v23, v5 offset:12032
    s_waitcnt lgkmcnt(0)
    v_add_f32 v6, v116, v117
    v_add_f32 v7, v16, v17
    v_add_f32 v6, v6, v118
    v_add_f32 v7, v7, v18
    v_add_f32 v6, v6, v119
    v_add_f32 v7, v7, v19
    v_add_f32 v6, v6, v120
    v_add_f32 v7, v7, v20
    v_add_f32 v6, v6, v121
    v_add_f32 v7, v7, v21
    v_add_f32 v6, v6, v122
    v_add_f32 v7, v7, v22
    v_add_f32 v6, v6, v123
    v_add_f32 v7, v7, v23
    v_cvt_pk_bf16_f32 v6, v6, v6
    v_lshlrev_b32 v6, 16, v6
    v_cvt_pk_bf16_f32 v7, v7, v7
    v_lshlrev_b32 v7, 16, v7
    v_mul_f32 v8, v6, v6
    v_mul_f32 v8, v8, v6
    v_mov_b32 v9, 0x3d372713
    v_fma_f32 v8, v8, v9, v6
    v_mul_f32 v8, 0xc0135761, v8
    v_exp_f32 v8, v8
    s_nop 0
    v_add_f32 v8, 1.0, v8
    v_rcp_f32 v8, v8
    s_nop 0
    v_mul_f32 v8, v6, v8
    v_cvt_pk_bf16_f32 v8, v8, v8
    v_lshlrev_b32 v8, 16, v8
    v_mul_f32 v8, v8, v7
    v_cvt_pk_bf16_f32 v8, v8, v8
    v_lshlrev_b32 v8, 16, v8
    ds_write_b32 v5, v8 offset:12544
L_k1_s2done:
    s_nop 4
    s_waitcnt lgkmcnt(0)
    s_barrier
    v_lshlrev_b32 v5, 4, v4
    ds_read_b128 v[124:127], v5 offset:12288
    s_lshl_b32 s73, s64, 4
    v_mov_b32 v6, s73
    ds_read_b128 v[8:11], v6 offset:12544
    v_lshrrev_b32 v7, 3, v2
    v_and_b32 v7, 3, v7
    v_lshl_add_u32 v7, v7, 2, v6
    ds_read_b32 v14, v7 offset:12544
    s_waitcnt lgkmcnt(0)
    v_readfirstlane_b32 s68, v8
    v_readfirstlane_b32 s69, v9
    v_readfirstlane_b32 s70, v10
    v_readfirstlane_b32 s71, v11
    s_waitcnt vmcnt(17)
    v_dot2_f32_bf16 v16, v88, v124, 0
    v_dot2_f32_bf16 v17, v92, v124, 0
    v_dot2_f32_bf16 v18, v96, v124, 0
    v_dot2_f32_bf16 v19, v100, v124, 0
    v_dot2_f32_bf16 v16, v89, v125, v16
    v_dot2_f32_bf16 v17, v93, v125, v17
    v_dot2_f32_bf16 v18, v97, v125, v18
    v_dot2_f32_bf16 v19, v101, v125, v19
    v_dot2_f32_bf16 v16, v90, v126, v16
    v_dot2_f32_bf16 v17, v94, v126, v17
    v_dot2_f32_bf16 v18, v98, v126, v18
    v_dot2_f32_bf16 v19, v102, v126, v19
    v_dot2_f32_bf16 v16, v91, v127, v16
    v_dot2_f32_bf16 v17, v95, v127, v17
    v_dot2_f32_bf16 v18, v99, v127, v18
    v_dot2_f32_bf16 v19, v103, v127, v19
    buffer_load_dwordx4 v[88:91], v1, s[32:35], s84 offen offset:0 nt
    buffer_load_dwordx4 v[92:95], v1, s[32:35], s84 offen offset:1024 nt
    buffer_load_dwordx4 v[96:99], v1, s[32:35], s84 offen offset:2048 nt
    buffer_load_dwordx4 v[100:103], v1, s[32:35], s84 offen offset:3072 nt
    v_add_f32_dpp v16, v16, v16 row_ror:8 row_mask:0xf bank_mask:0xf
    v_add_f32_dpp v17, v17, v17 row_ror:8 row_mask:0xf bank_mask:0xf
    v_add_f32_dpp v18, v18, v18 row_ror:8 row_mask:0xf bank_mask:0xf
    v_add_f32_dpp v19, v19, v19 row_ror:8 row_mask:0xf bank_mask:0xf
    v_add_f32_dpp v16, v16, v16 row_ror:4 row_mask:0xf bank_mask:0xf
    v_add_f32_dpp v17, v17, v17 row_ror:4 row_mask:0xf bank_mask:0xf
    v_add_f32_dpp v18, v18, v18 row_ror:4 row_mask:0xf bank_mask:0xf
    v_add_f32_dpp v19, v19, v19 row_ror:4 row_mask:0xf bank_mask:0xf
    v_add_f32_dpp v16, v16, v16 row_ror:2 row_mask:0xf bank_mask:0xf
    v_add_f32_dpp v17, v17, v17 row_ror:2 row_mask:0xf bank_mask:0xf
    v_add_f32_dpp v18, v18, v18 row_ror:2 row_mask:0xf bank_mask:0xf
    v_add_f32_dpp v19, v19, v19 row_ror:2 row_mask:0xf bank_mask:0xf
    v_add_f32_dpp v16, v16, v16 row_ror:1 row_mask:0xf bank_mask:0xf
    v_add_f32_dpp v17, v17, v17 row_ror:1 row_mask:0xf bank_mask:0xf
    v_add_f32_dpp v18, v18, v18 row_ror:1 row_mask:0xf bank_mask:0xf
    v_add_f32_dpp v19, v19, v19 row_ror:1 row_mask:0xf bank_mask:0xf
    v_cvt_pk_bf16_f32 v5, v16, v17
    v_cvt_pk_bf16_f32 v7, v18, v19
    v_lshlrev_b32 v16, 16, v5
    v_and_b32 v17, 0xffff0000, v5
    v_lshlrev_b32 v18, 16, v7
    v_and_b32 v19, 0xffff0000, v7
    v_mul_f32 v16, 0x3db504f3, v16
    v_mul_f32 v17, 0x3db504f3, v17
    v_mul_f32 v18, 0x3db504f3, v18
    v_mul_f32 v19, 0x3db504f3, v19
    v_cvt_pk_bf16_f32 v5, v16, v17
    v_cvt_pk_bf16_f32 v7, v18, v19
    v_lshlrev_b32 v16, 16, v5
    v_and_b32 v17, 0xffff0000, v5
    v_lshlrev_b32 v18, 16, v7
    v_and_b32 v19, 0xffff0000, v7
    s_waitcnt vmcnt(17)
    v_dot2_f32_bf16 v20, v104, v124, 0
    v_dot2_f32_bf16 v21, v108, v124, 0
    v_dot2_f32_bf16 v22, v112, v124, 0
    v_dot2_f32_bf16 v23, v52, v124, 0
    v_dot2_f32_bf16 v20, v105, v125, v20
    v_dot2_f32_bf16 v21, v109, v125, v21
    v_dot2_f32_bf16 v22, v113, v125, v22
    v_dot2_f32_bf16 v23, v53, v125, v23
    v_dot2_f32_bf16 v20, v106, v126, v20
    v_dot2_f32_bf16 v21, v110, v126, v21
    v_dot2_f32_bf16 v22, v114, v126, v22
    v_dot2_f32_bf16 v23, v54, v126, v23
    v_dot2_f32_bf16 v20, v107, v127, v20
    v_dot2_f32_bf16 v21, v111, v127, v21
    v_dot2_f32_bf16 v22, v115, v127, v22
    v_dot2_f32_bf16 v23, v55, v127, v23
    buffer_load_dwordx4 v[104:107], v1, s[32:35], s85 offen nt
    buffer_load_dwordx4 v[108:111], v1, s[32:35], s86 offen nt
    buffer_load_dwordx4 v[112:115], v1, s[32:35], s87 offen nt
    buffer_load_dwordx4 v[52:55], v1, s[32:35], s88 offen nt
    v_add_f32_dpp v20, v20, v20 row_ror:8 row_mask:0xf bank_mask:0xf
    v_add_f32_dpp v21, v21, v21 row_ror:8 row_mask:0xf bank_mask:0xf
    v_add_f32_dpp v22, v22, v22 row_ror:8 row_mask:0xf bank_mask:0xf
    v_add_f32_dpp v23, v23, v23 row_ror:8 row_mask:0xf bank_mask:0xf
    v_add_f32_dpp v20, v20, v20 row_ror:4 row_mask:0xf bank_mask:0xf
    v_add_f32_dpp v21, v21, v21 row_ror:4 row_mask:0xf bank_mask:0xf
    v_add_f32_dpp v22, v22, v22 row_ror:4 row_mask:0xf bank_mask:0xf
    v_add_f32_dpp v23, v23, v23 row_ror:4 row_mask:0xf bank_mask:0xf
    v_add_f32_dpp v20, v20, v20 row_ror:2 row_mask:0xf bank_mask:0xf
    v_add_f32_dpp v21, v21, v21 row_ror:2 row_mask:0xf bank_mask:0xf
    v_add_f32_dpp v22, v22, v22 row_ror:2 row_mask:0xf bank_mask:0xf
    v_add_f32_dpp v23, v23, v23 row_ror:2 row_mask:0xf bank_mask:0xf
    v_add_f32_dpp v20, v20, v20 row_ror:1 row_mask:0xf bank_mask:0xf
    v_add_f32_dpp v21, v21, v21 row_ror:1 row_mask:0xf bank_mask:0xf
    v_add_f32_dpp v22, v22, v22 row_ror:1 row_mask:0xf bank_mask:0xf
    v_add_f32_dpp v23, v23, v23 row_ror:1 row_mask:0xf bank_mask:0xf
    v_cvt_pk_bf16_f32 v5, v20, v21
    v_cvt_pk_bf16_f32 v7, v22, v23
    v_lshlrev_b32 v20, 16, v5
    v_and_b32 v21, 0xffff0000, v5
    v_lshlrev_b32 v22, 16, v7
    v_and_b32 v23, 0xffff0000, v7
    v_mul_f32 v20, 0x3db504f3, v20
    v_mul_f32 v21, 0x3db504f3, v21
    v_mul_f32 v22, 0x3db504f3, v22
    v_mul_f32 v23, 0x3db504f3, v23
    v_cvt_pk_bf16_f32 v5, v20, v21
    v_cvt_pk_bf16_f32 v7, v22, v23
    v_lshlrev_b32 v20, 16, v5
    v_and_b32 v21, 0xffff0000, v5
    v_lshlrev_b32 v22, 16, v7
    v_and_b32 v23, 0xffff0000, v7
    s_waitcnt vmcnt(17)
    v_dot2_f32_bf16 v24, v56, v124, 0
    v_dot2_f32_bf16 v25, v60, v124, 0
    v_dot2_f32_bf16 v26, v64, v124, 0
    v_dot2_f32_bf16 v27, v68, v124, 0
    v_dot2_f32_bf16 v24, v57, v125, v24
    v_dot2_f32_bf16 v25, v61, v125, v25
    v_dot2_f32_bf16 v26, v65, v125, v26
    v_dot2_f32_bf16 v27, v69, v125, v27
    v_dot2_f32_bf16 v24, v58, v126, v24
    v_dot2_f32_bf16 v25, v62, v126, v25
    v_dot2_f32_bf16 v26, v66, v126, v26
    v_dot2_f32_bf16 v27, v70, v126, v27
    v_dot2_f32_bf16 v24, v59, v127, v24
    v_dot2_f32_bf16 v25, v63, v127, v25
    v_dot2_f32_bf16 v26, v67, v127, v26
    v_dot2_f32_bf16 v27, v71, v127, v27
    buffer_load_dwordx4 v[56:59], v1, s[32:35], s89 offen nt
    buffer_load_dwordx4 v[60:63], v1, s[32:35], s90 offen nt
    buffer_load_dwordx4 v[64:67], v1, s[32:35], s91 offen nt
    buffer_load_dwordx4 v[68:71], v1, s[32:35], s92 offen nt
    v_add_f32_dpp v24, v24, v24 row_ror:8 row_mask:0xf bank_mask:0xf
    v_add_f32_dpp v25, v25, v25 row_ror:8 row_mask:0xf bank_mask:0xf
    v_add_f32_dpp v26, v26, v26 row_ror:8 row_mask:0xf bank_mask:0xf
    v_add_f32_dpp v27, v27, v27 row_ror:8 row_mask:0xf bank_mask:0xf
    v_add_f32_dpp v24, v24, v24 row_ror:4 row_mask:0xf bank_mask:0xf
    v_add_f32_dpp v25, v25, v25 row_ror:4 row_mask:0xf bank_mask:0xf
    v_add_f32_dpp v26, v26, v26 row_ror:4 row_mask:0xf bank_mask:0xf
    v_add_f32_dpp v27, v27, v27 row_ror:4 row_mask:0xf bank_mask:0xf
    v_add_f32_dpp v24, v24, v24 row_ror:2 row_mask:0xf bank_mask:0xf
    v_add_f32_dpp v25, v25, v25 row_ror:2 row_mask:0xf bank_mask:0xf
    v_add_f32_dpp v26, v26, v26 row_ror:2 row_mask:0xf bank_mask:0xf
    v_add_f32_dpp v27, v27, v27 row_ror:2 row_mask:0xf bank_mask:0xf
    v_add_f32_dpp v24, v24, v24 row_ror:1 row_mask:0xf bank_mask:0xf
    v_add_f32_dpp v25, v25, v25 row_ror:1 row_mask:0xf bank_mask:0xf
    v_add_f32_dpp v26, v26, v26 row_ror:1 row_mask:0xf bank_mask:0xf
    v_add_f32_dpp v27, v27, v27 row_ror:1 row_mask:0xf bank_mask:0xf
    v_cvt_pk_bf16_f32 v5, v24, v25
    v_cvt_pk_bf16_f32 v7, v26, v27
    v_lshlrev_b32 v24, 16, v5
    v_and_b32 v25, 0xffff0000, v5
    v_lshlrev_b32 v26, 16, v7
    v_and_b32 v27, 0xffff0000, v7
    v_mul_f32 v24, 0x3db504f3, v24
    v_mul_f32 v25, 0x3db504f3, v25
    v_mul_f32 v26, 0x3db504f3, v26
    v_mul_f32 v27, 0x3db504f3, v27
    v_cvt_pk_bf16_f32 v5, v24, v25
    v_cvt_pk_bf16_f32 v7, v26, v27
    v_lshlrev_b32 v24, 16, v5
    v_and_b32 v25, 0xffff0000, v5
    v_lshlrev_b32 v26, 16, v7
    v_and_b32 v27, 0xffff0000, v7
    s_waitcnt vmcnt(12)
    s_cmp_eq_u32 s67, -1
    s_cbranch_scc1 L_k1_nodown
    v_lshlrev_b32 v5, 16, v28
    v_and_b32 v6, 0xffff0000, v28
    v_lshlrev_b32 v7, 16, v29
    v_and_b32 v8, 0xffff0000, v29
    v_lshlrev_b32 v9, 16, v30
    v_and_b32 v10, 0xffff0000, v30
    v_lshlrev_b32 v11, 16, v31
    v_and_b32 v12, 0xffff0000, v31
    v_mul_f32 v116, s68, v5
    v_mul_f32 v117, s68, v6
    v_mul_f32 v118, s68, v7
    v_mul_f32 v119, s68, v8
    v_mul_f32 v120, s68, v9
    v_mul_f32 v121, s68, v10
    v_mul_f32 v122, s68, v11
    v_mul_f32 v123, s68, v12
    v_lshlrev_b32 v5, 16, v32
    v_and_b32 v6, 0xffff0000, v32
    v_lshlrev_b32 v7, 16, v33
    v_and_b32 v8, 0xffff0000, v33
    v_lshlrev_b32 v9, 16, v34
    v_and_b32 v10, 0xffff0000, v34
    v_lshlrev_b32 v11, 16, v35
    v_and_b32 v12, 0xffff0000, v35
    v_fmac_f32 v116, s69, v5
    v_fmac_f32 v117, s69, v6
    v_fmac_f32 v118, s69, v7
    v_fmac_f32 v119, s69, v8
    v_fmac_f32 v120, s69, v9
    v_fmac_f32 v121, s69, v10
    v_fmac_f32 v122, s69, v11
    v_fmac_f32 v123, s69, v12
    v_lshlrev_b32 v5, 16, v36
    v_and_b32 v6, 0xffff0000, v36
    v_lshlrev_b32 v7, 16, v37
    v_and_b32 v8, 0xffff0000, v37
    v_lshlrev_b32 v9, 16, v38
    v_and_b32 v10, 0xffff0000, v38
    v_lshlrev_b32 v11, 16, v39
    v_and_b32 v12, 0xffff0000, v39
    v_fmac_f32 v116, s70, v5
    v_fmac_f32 v117, s70, v6
    v_fmac_f32 v118, s70, v7
    v_fmac_f32 v119, s70, v8
    v_fmac_f32 v120, s70, v9
    v_fmac_f32 v121, s70, v10
    v_fmac_f32 v122, s70, v11
    v_fmac_f32 v123, s70, v12
    v_lshlrev_b32 v5, 16, v40
    v_and_b32 v6, 0xffff0000, v40
    v_lshlrev_b32 v7, 16, v41
    v_and_b32 v8, 0xffff0000, v41
    v_lshlrev_b32 v9, 16, v42
    v_and_b32 v10, 0xffff0000, v42
    v_lshlrev_b32 v11, 16, v43
    v_and_b32 v12, 0xffff0000, v43
    v_fmac_f32 v116, s71, v5
    v_fmac_f32 v117, s71, v6
    v_fmac_f32 v118, s71, v7
    v_fmac_f32 v119, s71, v8
    v_fmac_f32 v120, s71, v9
    v_fmac_f32 v121, s71, v10
    v_fmac_f32 v122, s71, v11
    v_fmac_f32 v123, s71, v12
    s_mul_i32 s73, s64, 2304
    s_add_u32 s73, s73, 58368
    v_lshlrev_b32 v5, 5, v2
    v_add_u32 v5, s73, v5
    ds_write_b128 v5, v[116:119]
    ds_write_b128 v5, v[120:123] offset:16
    v_cmp_gt_u32 vcc, 32, v2
    s_nop 1
    v_cndmask_b32 v14, 0, v14, vcc
    v_lshlrev_b32 v6, 16, v44
    v_and_b32 v7, 0xffff0000, v44
    v_cndmask_b32 v6, 0, v6, vcc
    v_cndmask_b32 v7, 0, v7, vcc
    v_mul_f32 v28, v14, v6
    v_mul_f32 v29, v14, v7
    v_lshlrev_b32 v6, 16, v45
    v_and_b32 v7, 0xffff0000, v45
    v_cndmask_b32 v6, 0, v6, vcc
    v_cndmask_b32 v7, 0, v7, vcc
    v_mul_f32 v30, v14, v6
    v_mul_f32 v31, v14, v7
    v_lshlrev_b32 v6, 16, v46
    v_and_b32 v7, 0xffff0000, v46
    v_cndmask_b32 v6, 0, v6, vcc
    v_cndmask_b32 v7, 0, v7, vcc
    v_mul_f32 v32, v14, v6
    v_mul_f32 v33, v14, v7
    v_lshlrev_b32 v6, 16, v47
    v_and_b32 v7, 0xffff0000, v47
    v_cndmask_b32 v6, 0, v6, vcc
    v_cndmask_b32 v7, 0, v7, vcc
    v_mul_f32 v34, v14, v6
    v_mul_f32 v35, v14, v7
    v_permlane32_swap_b32 v28, v29
    v_permlane32_swap_b32 v30, v31
    v_add_f32 v28, v28, v29
    v_add_f32 v30, v30, v31
    s_nop 1
    v_permlane16_swap_b32 v28, v30
    v_add_f32 v28, v28, v30
    v_permlane32_swap_b32 v32, v33
    v_permlane32_swap_b32 v34, v35
    v_add_f32 v32, v32, v33
    v_add_f32 v34, v34, v35
    s_nop 1
    v_permlane16_swap_b32 v32, v34
    v_add_f32 v32, v32, v34
    v_add_f32_dpp v28, v28, v28 row_ror:8 row_mask:0xf bank_mask:0xf
    s_nop 0
    v_add_f32_dpp v32, v32, v32 row_ror:8 row_mask:0xf bank_mask:0xf
    v_and_b32 v5, 7, v4
    v_lshl_add_u32 v5, v5, 3, v15
    v_lshlrev_b32 v5, 2, v5
    v_add_u32 v5, s73, v5
    ds_write_b32 v5, v28 offset:2048
    ds_write_b32 v5, v32 offset:2064
    s_waitcnt lgkmcnt(0)
L_k1_nodown:
    s_nop 4
    s_waitcnt vmcnt(17)
    v_dot2_f32_bf16 v28, v72, v124, 0
    v_dot2_f32_bf16 v29, v76, v124, 0
    v_dot2_f32_bf16 v30, v80, v124, 0
    v_dot2_f32_bf16 v31, v84, v124, 0
    v_dot2_f32_bf16 v28, v73, v125, v28
    v_dot2_f32_bf16 v29, v77, v125, v29
    v_dot2_f32_bf16 v30, v81, v125, v30
    v_dot2_f32_bf16 v31, v85, v125, v31
    v_dot2_f32_bf16 v28, v74, v126, v28
    v_dot2_f32_bf16 v29, v78, v126, v29
    v_dot2_f32_bf16 v30, v82, v126, v30
    v_dot2_f32_bf16 v31, v86, v126, v31
    v_dot2_f32_bf16 v28, v75, v127, v28
    v_dot2_f32_bf16 v29, v79, v127, v29
    v_dot2_f32_bf16 v30, v83, v127, v30
    v_dot2_f32_bf16 v31, v87, v127, v31
    buffer_load_dwordx4 v[72:75], v1, s[32:35], s93 offen nt
    buffer_load_dwordx4 v[76:79], v1, s[32:35], s94 offen nt
    buffer_load_dwordx4 v[80:83], v1, s[32:35], s95 offen nt
    buffer_load_dwordx4 v[84:87], v1, s[32:35], s96 offen nt
    v_add_f32_dpp v28, v28, v28 row_ror:8 row_mask:0xf bank_mask:0xf
    v_add_f32_dpp v29, v29, v29 row_ror:8 row_mask:0xf bank_mask:0xf
    v_add_f32_dpp v30, v30, v30 row_ror:8 row_mask:0xf bank_mask:0xf
    v_add_f32_dpp v31, v31, v31 row_ror:8 row_mask:0xf bank_mask:0xf
    v_add_f32_dpp v28, v28, v28 row_ror:4 row_mask:0xf bank_mask:0xf
    v_add_f32_dpp v29, v29, v29 row_ror:4 row_mask:0xf bank_mask:0xf
    v_add_f32_dpp v30, v30, v30 row_ror:4 row_mask:0xf bank_mask:0xf
    v_add_f32_dpp v31, v31, v31 row_ror:4 row_mask:0xf bank_mask:0xf
    v_add_f32_dpp v28, v28, v28 row_ror:2 row_mask:0xf bank_mask:0xf
    v_add_f32_dpp v29, v29, v29 row_ror:2 row_mask:0xf bank_mask:0xf
    v_add_f32_dpp v30, v30, v30 row_ror:2 row_mask:0xf bank_mask:0xf
    v_add_f32_dpp v31, v31, v31 row_ror:2 row_mask:0xf bank_mask:0xf
    v_add_f32_dpp v28, v28, v28 row_ror:1 row_mask:0xf bank_mask:0xf
    v_add_f32_dpp v29, v29, v29 row_ror:1 row_mask:0xf bank_mask:0xf
    v_add_f32_dpp v30, v30, v30 row_ror:1 row_mask:0xf bank_mask:0xf
    v_add_f32_dpp v31, v31, v31 row_ror:1 row_mask:0xf bank_mask:0xf
    v_cvt_pk_bf16_f32 v5, v28, v29
    v_cvt_pk_bf16_f32 v7, v30, v31
    v_lshlrev_b32 v28, 16, v5
    v_and_b32 v29, 0xffff0000, v5
    v_lshlrev_b32 v30, 16, v7
    v_and_b32 v31, 0xffff0000, v7
    v_mul_f32 v28, 0x3db504f3, v28
    v_mul_f32 v29, 0x3db504f3, v29
    v_mul_f32 v30, 0x3db504f3, v30
    v_mul_f32 v31, 0x3db504f3, v31
    v_cvt_pk_bf16_f32 v5, v28, v29
    v_cvt_pk_bf16_f32 v7, v30, v31
    v_lshlrev_b32 v28, 16, v5
    v_and_b32 v29, 0xffff0000, v5
    v_lshlrev_b32 v30, 16, v7
    v_and_b32 v31, 0xffff0000, v7
    s_waitcnt vmcnt(12)
    v_dot2_f32_bf16 v32, v88, v124, 0
    v_dot2_f32_bf16 v33, v92, v124, 0
    v_dot2_f32_bf16 v34, v96, v124, 0
    v_dot2_f32_bf16 v35, v100, v124, 0
    v_dot2_f32_bf16 v32, v89, v125, v32
    v_dot2_f32_bf16 v33, v93, v125, v33
    v_dot2_f32_bf16 v34, v97, v125, v34
    v_dot2_f32_bf16 v35, v101, v125, v35
    v_dot2_f32_bf16 v32, v90, v126, v32
    v_dot2_f32_bf16 v33, v94, v126, v33
    v_dot2_f32_bf16 v34, v98, v126, v34
    v_dot2_f32_bf16 v35, v102, v126, v35
    v_dot2_f32_bf16 v32, v91, v127, v32
    v_dot2_f32_bf16 v33, v95, v127, v33
    v_dot2_f32_bf16 v34, v99, v127, v34
    v_dot2_f32_bf16 v35, v103, v127, v35
    buffer_load_dwordx4 v[88:91], v1, s[32:35], s97 offen nt
    buffer_load_dwordx4 v[92:95], v1, s[32:35], s98 offen nt
    buffer_load_dwordx4 v[96:99], v1, s[32:35], s99 offen nt
    buffer_load_dwordx4 v[100:103], v1, s[32:35], s100 offen nt
    v_add_f32_dpp v32, v32, v32 row_ror:8 row_mask:0xf bank_mask:0xf
    v_add_f32_dpp v33, v33, v33 row_ror:8 row_mask:0xf bank_mask:0xf
    v_add_f32_dpp v34, v34, v34 row_ror:8 row_mask:0xf bank_mask:0xf
    v_add_f32_dpp v35, v35, v35 row_ror:8 row_mask:0xf bank_mask:0xf
    v_add_f32_dpp v32, v32, v32 row_ror:4 row_mask:0xf bank_mask:0xf
    v_add_f32_dpp v33, v33, v33 row_ror:4 row_mask:0xf bank_mask:0xf
    v_add_f32_dpp v34, v34, v34 row_ror:4 row_mask:0xf bank_mask:0xf
    v_add_f32_dpp v35, v35, v35 row_ror:4 row_mask:0xf bank_mask:0xf
    v_add_f32_dpp v32, v32, v32 row_ror:2 row_mask:0xf bank_mask:0xf
    v_add_f32_dpp v33, v33, v33 row_ror:2 row_mask:0xf bank_mask:0xf
    v_add_f32_dpp v34, v34, v34 row_ror:2 row_mask:0xf bank_mask:0xf
    v_add_f32_dpp v35, v35, v35 row_ror:2 row_mask:0xf bank_mask:0xf
    v_add_f32_dpp v32, v32, v32 row_ror:1 row_mask:0xf bank_mask:0xf
    v_add_f32_dpp v33, v33, v33 row_ror:1 row_mask:0xf bank_mask:0xf
    v_add_f32_dpp v34, v34, v34 row_ror:1 row_mask:0xf bank_mask:0xf
    v_add_f32_dpp v35, v35, v35 row_ror:1 row_mask:0xf bank_mask:0xf
    v_cvt_pk_bf16_f32 v5, v32, v33
    v_cvt_pk_bf16_f32 v7, v34, v35
    v_lshlrev_b32 v32, 16, v5
    v_and_b32 v33, 0xffff0000, v5
    v_lshlrev_b32 v34, 16, v7
    v_and_b32 v35, 0xffff0000, v7
    v_mul_f32 v32, 0x3db504f3, v32
    v_mul_f32 v33, 0x3db504f3, v33
    v_mul_f32 v34, 0x3db504f3, v34
    v_mul_f32 v35, 0x3db504f3, v35
    v_cvt_pk_bf16_f32 v5, v32, v33
    v_cvt_pk_bf16_f32 v7, v34, v35
    v_lshlrev_b32 v32, 16, v5
    v_and_b32 v33, 0xffff0000, v5
    v_lshlrev_b32 v34, 16, v7
    v_and_b32 v35, 0xffff0000, v7
    s_waitcnt vmcnt(12)
    v_dot2_f32_bf16 v36, v104, v124, 0
    v_dot2_f32_bf16 v37, v108, v124, 0
    v_dot2_f32_bf16 v38, v112, v124, 0
    v_dot2_f32_bf16 v39, v52, v124, 0
    v_dot2_f32_bf16 v36, v105, v125, v36
    v_dot2_f32_bf16 v37, v109, v125, v37
    v_dot2_f32_bf16 v38, v113, v125, v38
    v_dot2_f32_bf16 v39, v53, v125, v39
    v_dot2_f32_bf16 v36, v106, v126, v36
    v_dot2_f32_bf16 v37, v110, v126, v37
    v_dot2_f32_bf16 v38, v114, v126, v38
    v_dot2_f32_bf16 v39, v54, v126, v39
    v_dot2_f32_bf16 v36, v107, v127, v36
    v_dot2_f32_bf16 v37, v111, v127, v37
    v_dot2_f32_bf16 v38, v115, v127, v38
    v_dot2_f32_bf16 v39, v55, v127, v39
    buffer_load_dwordx4 v[104:107], v1, s[36:39], s80 offen offset:0 nt
    buffer_load_dwordx4 v[108:111], v1, s[36:39], s80 offen offset:1024 nt
    buffer_load_dwordx4 v[112:115], v1, s[36:39], s80 offen offset:2048 nt
    buffer_load_dwordx4 v[52:55], v1, s[36:39], s80 offen offset:3072 nt
    v_add_f32_dpp v36, v36, v36 row_ror:8 row_mask:0xf bank_mask:0xf
    v_add_f32_dpp v37, v37, v37 row_ror:8 row_mask:0xf bank_mask:0xf
    v_add_f32_dpp v38, v38, v38 row_ror:8 row_mask:0xf bank_mask:0xf
    v_add_f32_dpp v39, v39, v39 row_ror:8 row_mask:0xf bank_mask:0xf
    v_add_f32_dpp v36, v36, v36 row_ror:4 row_mask:0xf bank_mask:0xf
    v_add_f32_dpp v37, v37, v37 row_ror:4 row_mask:0xf bank_mask:0xf
    v_add_f32_dpp v38, v38, v38 row_ror:4 row_mask:0xf bank_mask:0xf
    v_add_f32_dpp v39, v39, v39 row_ror:4 row_mask:0xf bank_mask:0xf
    v_add_f32_dpp v36, v36, v36 row_ror:2 row_mask:0xf bank_mask:0xf
    v_add_f32_dpp v37, v37, v37 row_ror:2 row_mask:0xf bank_mask:0xf
    v_add_f32_dpp v38, v38, v38 row_ror:2 row_mask:0xf bank_mask:0xf
    v_add_f32_dpp v39, v39, v39 row_ror:2 row_mask:0xf bank_mask:0xf
    v_add_f32_dpp v36, v36, v36 row_ror:1 row_mask:0xf bank_mask:0xf
    v_add_f32_dpp v37, v37, v37 row_ror:1 row_mask:0xf bank_mask:0xf
    v_add_f32_dpp v38, v38, v38 row_ror:1 row_mask:0xf bank_mask:0xf
    v_add_f32_dpp v39, v39, v39 row_ror:1 row_mask:0xf bank_mask:0xf
    v_cvt_pk_bf16_f32 v5, v36, v37
    v_cvt_pk_bf16_f32 v7, v38, v39
    v_lshlrev_b32 v36, 16, v5
    v_and_b32 v37, 0xffff0000, v5
    v_lshlrev_b32 v38, 16, v7
    v_and_b32 v39, 0xffff0000, v7
    v_mul_f32 v36, 0x3db504f3, v36
    v_mul_f32 v37, 0x3db504f3, v37
    v_mul_f32 v38, 0x3db504f3, v38
    v_mul_f32 v39, 0x3db504f3, v39
    v_cvt_pk_bf16_f32 v5, v36, v37
    v_cvt_pk_bf16_f32 v7, v38, v39
    v_lshlrev_b32 v36, 16, v5
    v_and_b32 v37, 0xffff0000, v5
    v_lshlrev_b32 v38, 16, v7
    v_and_b32 v39, 0xffff0000, v7
    s_cmp_lt_u32 20, s79
    s_cselect_b32 s73, 0, 0xf149f2ca
    v_add_f32 v36, s73, v36
    s_cmp_lt_u32 21, s79
    s_cselect_b32 s73, 0, 0xf149f2ca
    v_add_f32 v37, s73, v37
    s_cmp_lt_u32 22, s79
    s_cselect_b32 s73, 0, 0xf149f2ca
    v_add_f32 v38, s73, v38
    s_cmp_lt_u32 23, s79
    s_cselect_b32 s73, 0, 0xf149f2ca
    v_add_f32 v39, s73, v39
    s_waitcnt vmcnt(12)
    v_dot2_f32_bf16 v40, v56, v124, 0
    v_dot2_f32_bf16 v41, v60, v124, 0
    v_dot2_f32_bf16 v42, v64, v124, 0
    v_dot2_f32_bf16 v43, v68, v124, 0
    v_dot2_f32_bf16 v40, v57, v125, v40
    v_dot2_f32_bf16 v41, v61, v125, v41
    v_dot2_f32_bf16 v42, v65, v125, v42
    v_dot2_f32_bf16 v43, v69, v125, v43
    v_dot2_f32_bf16 v40, v58, v126, v40
    v_dot2_f32_bf16 v41, v62, v126, v41
    v_dot2_f32_bf16 v42, v66, v126, v42
    v_dot2_f32_bf16 v43, v70, v126, v43
    v_dot2_f32_bf16 v40, v59, v127, v40
    v_dot2_f32_bf16 v41, v63, v127, v41
    v_dot2_f32_bf16 v42, v67, v127, v42
    v_dot2_f32_bf16 v43, v71, v127, v43
    buffer_load_dwordx4 v[56:59], v1, s[36:39], s81 offen offset:0 nt
    buffer_load_dwordx4 v[60:63], v1, s[36:39], s81 offen offset:1024 nt
    buffer_load_dwordx4 v[64:67], v1, s[36:39], s81 offen offset:2048 nt
    buffer_load_dwordx4 v[68:71], v1, s[36:39], s81 offen offset:3072 nt
    v_add_f32_dpp v40, v40, v40 row_ror:8 row_mask:0xf bank_mask:0xf
    v_add_f32_dpp v41, v41, v41 row_ror:8 row_mask:0xf bank_mask:0xf
    v_add_f32_dpp v42, v42, v42 row_ror:8 row_mask:0xf bank_mask:0xf
    v_add_f32_dpp v43, v43, v43 row_ror:8 row_mask:0xf bank_mask:0xf
    v_add_f32_dpp v40, v40, v40 row_ror:4 row_mask:0xf bank_mask:0xf
    v_add_f32_dpp v41, v41, v41 row_ror:4 row_mask:0xf bank_mask:0xf
    v_add_f32_dpp v42, v42, v42 row_ror:4 row_mask:0xf bank_mask:0xf
    v_add_f32_dpp v43, v43, v43 row_ror:4 row_mask:0xf bank_mask:0xf
    v_add_f32_dpp v40, v40, v40 row_ror:2 row_mask:0xf bank_mask:0xf
    v_add_f32_dpp v41, v41, v41 row_ror:2 row_mask:0xf bank_mask:0xf
    v_add_f32_dpp v42, v42, v42 row_ror:2 row_mask:0xf bank_mask:0xf
    v_add_f32_dpp v43, v43, v43 row_ror:2 row_mask:0xf bank_mask:0xf
    v_add_f32_dpp v40, v40, v40 row_ror:1 row_mask:0xf bank_mask:0xf
    v_add_f32_dpp v41, v41, v41 row_ror:1 row_mask:0xf bank_mask:0xf
    v_add_f32_dpp v42, v42, v42 row_ror:1 row_mask:0xf bank_mask:0xf
    v_add_f32_dpp v43, v43, v43 row_ror:1 row_mask:0xf bank_mask:0xf
    v_cvt_pk_bf16_f32 v5, v40, v41
    v_cvt_pk_bf16_f32 v7, v42, v43
    v_lshlrev_b32 v40, 16, v5
    v_and_b32 v41, 0xffff0000, v5
    v_lshlrev_b32 v42, 16, v7
    v_and_b32 v43, 0xffff0000, v7
    v_mul_f32 v40, 0x3db504f3, v40
    v_mul_f32 v41, 0x3db504f3, v41
    v_mul_f32 v42, 0x3db504f3, v42
    v_mul_f32 v43, 0x3db504f3, v43
    v_cvt_pk_bf16_f32 v5, v40, v41
    v_cvt_pk_bf16_f32 v7, v42, v43
    v_lshlrev_b32 v40, 16, v5
    v_and_b32 v41, 0xffff0000, v5
    v_lshlrev_b32 v42, 16, v7
    v_and_b32 v43, 0xffff0000, v7
    s_cmp_lt_u32 24, s79
    s_cselect_b32 s73, 0, 0xf149f2ca
    v_add_f32 v40, s73, v40
    s_cmp_lt_u32 25, s79
    s_cselect_b32 s73, 0, 0xf149f2ca
    v_add_f32 v41, s73, v41
    s_cmp_lt_u32 26, s79
    s_cselect_b32 s73, 0, 0xf149f2ca
    v_add_f32 v42, s73, v42
    s_cmp_lt_u32 27, s79
    s_cselect_b32 s73, 0, 0xf149f2ca
    v_add_f32 v43, s73, v43
    s_waitcnt vmcnt(12)
    v_dot2_f32_bf16 v44, v72, v124, 0
    v_dot2_f32_bf16 v45, v76, v124, 0
    v_dot2_f32_bf16 v46, v80, v124, 0
    v_dot2_f32_bf16 v47, v84, v124, 0
    v_dot2_f32_bf16 v44, v73, v125, v44
    v_dot2_f32_bf16 v45, v77, v125, v45
    v_dot2_f32_bf16 v46, v81, v125, v46
    v_dot2_f32_bf16 v47, v85, v125, v47
    v_dot2_f32_bf16 v44, v74, v126, v44
    v_dot2_f32_bf16 v45, v78, v126, v45
    v_dot2_f32_bf16 v46, v82, v126, v46
    v_dot2_f32_bf16 v47, v86, v126, v47
    v_dot2_f32_bf16 v44, v75, v127, v44
    v_dot2_f32_bf16 v45, v79, v127, v45
    v_dot2_f32_bf16 v46, v83, v127, v46
    v_dot2_f32_bf16 v47, v87, v127, v47
    buffer_load_dwordx4 v[72:75], v1, s[36:39], s82 offen offset:0 nt
    buffer_load_dwordx4 v[76:79], v1, s[36:39], s82 offen offset:1024 nt
    buffer_load_dwordx4 v[80:83], v1, s[36:39], s82 offen offset:2048 nt
    buffer_load_dwordx4 v[84:87], v1, s[36:39], s82 offen offset:3072 nt
    v_add_f32_dpp v44, v44, v44 row_ror:8 row_mask:0xf bank_mask:0xf
    v_add_f32_dpp v45, v45, v45 row_ror:8 row_mask:0xf bank_mask:0xf
    v_add_f32_dpp v46, v46, v46 row_ror:8 row_mask:0xf bank_mask:0xf
    v_add_f32_dpp v47, v47, v47 row_ror:8 row_mask:0xf bank_mask:0xf
    v_add_f32_dpp v44, v44, v44 row_ror:4 row_mask:0xf bank_mask:0xf
    v_add_f32_dpp v45, v45, v45 row_ror:4 row_mask:0xf bank_mask:0xf
    v_add_f32_dpp v46, v46, v46 row_ror:4 row_mask:0xf bank_mask:0xf
    v_add_f32_dpp v47, v47, v47 row_ror:4 row_mask:0xf bank_mask:0xf
    v_add_f32_dpp v44, v44, v44 row_ror:2 row_mask:0xf bank_mask:0xf
    v_add_f32_dpp v45, v45, v45 row_ror:2 row_mask:0xf bank_mask:0xf
    v_add_f32_dpp v46, v46, v46 row_ror:2 row_mask:0xf bank_mask:0xf
    v_add_f32_dpp v47, v47, v47 row_ror:2 row_mask:0xf bank_mask:0xf
    v_add_f32_dpp v44, v44, v44 row_ror:1 row_mask:0xf bank_mask:0xf
    v_add_f32_dpp v45, v45, v45 row_ror:1 row_mask:0xf bank_mask:0xf
    v_add_f32_dpp v46, v46, v46 row_ror:1 row_mask:0xf bank_mask:0xf
    v_add_f32_dpp v47, v47, v47 row_ror:1 row_mask:0xf bank_mask:0xf
    v_cvt_pk_bf16_f32 v5, v44, v45
    v_cvt_pk_bf16_f32 v7, v46, v47
    v_lshlrev_b32 v44, 16, v5
    v_and_b32 v45, 0xffff0000, v5
    v_lshlrev_b32 v46, 16, v7
    v_and_b32 v47, 0xffff0000, v7
    v_mul_f32 v44, 0x3db504f3, v44
    v_mul_f32 v45, 0x3db504f3, v45
    v_mul_f32 v46, 0x3db504f3, v46
    v_mul_f32 v47, 0x3db504f3, v47
    v_cvt_pk_bf16_f32 v5, v44, v45
    v_cvt_pk_bf16_f32 v7, v46, v47
    v_lshlrev_b32 v44, 16, v5
    v_and_b32 v45, 0xffff0000, v5
    v_lshlrev_b32 v46, 16, v7
    v_and_b32 v47, 0xffff0000, v7
    s_cmp_lt_u32 28, s79
    s_cselect_b32 s73, 0, 0xf149f2ca
    v_add_f32 v44, s73, v44
    s_cmp_lt_u32 29, s79
    s_cselect_b32 s73, 0, 0xf149f2ca
    v_add_f32 v45, s73, v45
    s_cmp_lt_u32 30, s79
    s_cselect_b32 s73, 0, 0xf149f2ca
    v_add_f32 v46, s73, v46
    s_cmp_lt_u32 31, s79
    s_cselect_b32 s73, 0, 0xf149f2ca
    v_add_f32 v47, s73, v47
    s_waitcnt vmcnt(12)
    v_dot2_f32_bf16 v48, v88, v124, 0
    v_dot2_f32_bf16 v49, v92, v124, 0
    v_dot2_f32_bf16 v50, v96, v124, 0
    v_dot2_f32_bf16 v51, v100, v124, 0
    v_dot2_f32_bf16 v48, v89, v125, v48
    v_dot2_f32_bf16 v49, v93, v125, v49
    v_dot2_f32_bf16 v50, v97, v125, v50
    v_dot2_f32_bf16 v51, v101, v125, v51
    v_dot2_f32_bf16 v48, v90, v126, v48
    v_dot2_f32_bf16 v49, v94, v126, v49
    v_dot2_f32_bf16 v50, v98, v126, v50
    v_dot2_f32_bf16 v51, v102, v126, v51
    v_dot2_f32_bf16 v48, v91, v127, v48
    v_dot2_f32_bf16 v49, v95, v127, v49
    v_dot2_f32_bf16 v50, v99, v127, v50
    v_dot2_f32_bf16 v51, v103, v127, v51
    buffer_load_dwordx4 v[88:91], v1, s[36:39], s83 offen offset:0 nt
    buffer_load_dwordx4 v[92:95], v1, s[36:39], s83 offen offset:1024 nt
    buffer_load_dwordx4 v[96:99], v1, s[36:39], s83 offen offset:2048 nt
    buffer_load_dwordx4 v[100:103], v1, s[36:39], s83 offen offset:3072 nt
    v_add_f32_dpp v48, v48, v48 row_ror:8 row_mask:0xf bank_mask:0xf
    v_add_f32_dpp v49, v49, v49 row_ror:8 row_mask:0xf bank_mask:0xf
    v_add_f32_dpp v50, v50, v50 row_ror:8 row_mask:0xf bank_mask:0xf
    v_add_f32_dpp v51, v51, v51 row_ror:8 row_mask:0xf bank_mask:0xf
    v_add_f32_dpp v48, v48, v48 row_ror:4 row_mask:0xf bank_mask:0xf
    v_add_f32_dpp v49, v49, v49 row_ror:4 row_mask:0xf bank_mask:0xf
    v_add_f32_dpp v50, v50, v50 row_ror:4 row_mask:0xf bank_mask:0xf
    v_add_f32_dpp v51, v51, v51 row_ror:4 row_mask:0xf bank_mask:0xf
    v_add_f32_dpp v48, v48, v48 row_ror:2 row_mask:0xf bank_mask:0xf
    v_add_f32_dpp v49, v49, v49 row_ror:2 row_mask:0xf bank_mask:0xf
    v_add_f32_dpp v50, v50, v50 row_ror:2 row_mask:0xf bank_mask:0xf
    v_add_f32_dpp v51, v51, v51 row_ror:2 row_mask:0xf bank_mask:0xf
    v_add_f32_dpp v48, v48, v48 row_ror:1 row_mask:0xf bank_mask:0xf
    v_add_f32_dpp v49, v49, v49 row_ror:1 row_mask:0xf bank_mask:0xf
    v_add_f32_dpp v50, v50, v50 row_ror:1 row_mask:0xf bank_mask:0xf
    v_add_f32_dpp v51, v51, v51 row_ror:1 row_mask:0xf bank_mask:0xf
    v_cvt_pk_bf16_f32 v5, v48, v49
    v_cvt_pk_bf16_f32 v7, v50, v51
    v_lshlrev_b32 v48, 16, v5
    v_and_b32 v49, 0xffff0000, v5
    v_lshlrev_b32 v50, 16, v7
    v_and_b32 v51, 0xffff0000, v7
    v_mul_f32 v48, 0x3db504f3, v48
    v_mul_f32 v49, 0x3db504f3, v49
    v_mul_f32 v50, 0x3db504f3, v50
    v_mul_f32 v51, 0x3db504f3, v51
    v_cvt_pk_bf16_f32 v5, v48, v49
    v_cvt_pk_bf16_f32 v7, v50, v51
    v_lshlrev_b32 v48, 16, v5
    v_and_b32 v49, 0xffff0000, v5
    v_lshlrev_b32 v50, 16, v7
    v_and_b32 v51, 0xffff0000, v7
    s_cmp_lt_u32 32, s79
    s_cselect_b32 s73, 0, 0xf149f2ca
    v_add_f32 v48, s73, v48
    s_cmp_lt_u32 33, s79
    s_cselect_b32 s73, 0, 0xf149f2ca
    v_add_f32 v49, s73, v49
    s_cmp_lt_u32 34, s79
    s_cselect_b32 s73, 0, 0xf149f2ca
    v_add_f32 v50, s73, v50
    s_cmp_lt_u32 35, s79
    s_cselect_b32 s73, 0, 0xf149f2ca
    v_add_f32 v51, s73, v51
    v_max_f32 v5, v16, v17
    v_max3_f32 v5, v5, v18, v19
    v_max3_f32 v5, v5, v20, v21
    v_max3_f32 v5, v5, v22, v23
    v_max3_f32 v5, v5, v24, v25
    v_max3_f32 v5, v5, v26, v27
    v_max3_f32 v5, v5, v28, v29
    v_max3_f32 v5, v5, v30, v31
    v_max3_f32 v5, v5, v32, v33
    v_max3_f32 v5, v5, v34, v35
    v_max3_f32 v5, v5, v36, v37
    v_max3_f32 v5, v5, v38, v39
    v_max3_f32 v5, v5, v40, v41
    v_max3_f32 v5, v5, v42, v43
    v_max3_f32 v5, v5, v44, v45
    v_max3_f32 v5, v5, v46, v47
    v_max3_f32 v5, v5, v48, v49
    v_max3_f32 v5, v5, v50, v51
    v_mov_b32 v6, v5
    s_nop 1
    v_permlane32_swap_b32 v5, v6
    v_max_f32 v5, v5, v6
    v_mov_b32 v6, v5
    s_nop 1
    v_permlane16_swap_b32 v5, v6
    v_max_f32 v5, v5, v6
    s_lshl_b32 s73, s64, 2
    v_mov_b32 v6, s73
    ds_write_b32 v6, v5 offset:12800
    s_waitcnt lgkmcnt(0)
    s_barrier
    v_and_b32 v6, 15, v2
    v_lshlrev_b32 v6, 2, v6
    ds_read_b32 v14, v6 offset:12800
    s_waitcnt lgkmcnt(0)
    v_max_f32_dpp v14, v14, v14 row_ror:8 row_mask:0xf bank_mask:0xf
    s_nop 1
    v_max_f32_dpp v14, v14, v14 row_ror:4 row_mask:0xf bank_mask:0xf
    s_nop 1
    v_max_f32_dpp v14, v14, v14 row_ror:2 row_mask:0xf bank_mask:0xf
    s_nop 1
    v_max_f32_dpp v14, v14, v14 row_ror:1 row_mask:0xf bank_mask:0xf
    v_mov_b32 v6, 0x3fb8aa3b
    v_sub_f32 v16, v16, v14
    v_mul_f32 v16, v16, v6
    v_exp_f32 v16, v16
    v_sub_f32 v17, v17, v14
    v_mul_f32 v17, v17, v6
    v_exp_f32 v17, v17
    v_sub_f32 v18, v18, v14
    v_mul_f32 v18, v18, v6
    v_exp_f32 v18, v18
    v_sub_f32 v19, v19, v14
    v_mul_f32 v19, v19, v6
    v_exp_f32 v19, v19
    v_sub_f32 v20, v20, v14
    v_mul_f32 v20, v20, v6
    v_exp_f32 v20, v20
    v_sub_f32 v21, v21, v14
    v_mul_f32 v21, v21, v6
    v_exp_f32 v21, v21
    v_sub_f32 v22, v22, v14
    v_mul_f32 v22, v22, v6
    v_exp_f32 v22, v22
    v_sub_f32 v23, v23, v14
    v_mul_f32 v23, v23, v6
    v_exp_f32 v23, v23
    v_sub_f32 v24, v24, v14
    v_mul_f32 v24, v24, v6
    v_exp_f32 v24, v24
    v_sub_f32 v25, v25, v14
    v_mul_f32 v25, v25, v6
    v_exp_f32 v25, v25
    v_sub_f32 v26, v26, v14
    v_mul_f32 v26, v26, v6
    v_exp_f32 v26, v26
    v_sub_f32 v27, v27, v14
    v_mul_f32 v27, v27, v6
    v_exp_f32 v27, v27
    v_sub_f32 v28, v28, v14
    v_mul_f32 v28, v28, v6
    v_exp_f32 v28, v28
    v_sub_f32 v29, v29, v14
    v_mul_f32 v29, v29, v6
    v_exp_f32 v29, v29
    v_sub_f32 v30, v30, v14
    v_mul_f32 v30, v30, v6
    v_exp_f32 v30, v30
    v_sub_f32 v31, v31, v14
    v_mul_f32 v31, v31, v6
    v_exp_f32 v31, v31
    v_sub_f32 v32, v32, v14
    v_mul_f32 v32, v32, v6
    v_exp_f32 v32, v32
    v_sub_f32 v33, v33, v14
    v_mul_f32 v33, v33, v6
    v_exp_f32 v33, v33
    v_sub_f32 v34, v34, v14
    v_mul_f32 v34, v34, v6
    v_exp_f32 v34, v34
    v_sub_f32 v35, v35, v14
    v_mul_f32 v35, v35, v6
    v_exp_f32 v35, v35
    v_sub_f32 v36, v36, v14
    v_mul_f32 v36, v36, v6
    v_exp_f32 v36, v36
    v_sub_f32 v37, v37, v14
    v_mul_f32 v37, v37, v6
    v_exp_f32 v37, v37
    v_sub_f32 v38, v38, v14
    v_mul_f32 v38, v38, v6
    v_exp_f32 v38, v38
    v_sub_f32 v39, v39, v14
    v_mul_f32 v39, v39, v6
    v_exp_f32 v39, v39
    v_sub_f32 v40, v40, v14
    v_mul_f32 v40, v40, v6
    v_exp_f32 v40, v40
    v_sub_f32 v41, v41, v14
    v_mul_f32 v41, v41, v6
    v_exp_f32 v41, v41
    v_sub_f32 v42, v42, v14
    v_mul_f32 v42, v42, v6
    v_exp_f32 v42, v42
    v_sub_f32 v43, v43, v14
    v_mul_f32 v43, v43, v6
    v_exp_f32 v43, v43
    v_sub_f32 v44, v44, v14
    v_mul_f32 v44, v44, v6
    v_exp_f32 v44, v44
    v_sub_f32 v45, v45, v14
    v_mul_f32 v45, v45, v6
    v_exp_f32 v45, v45
    v_sub_f32 v46, v46, v14
    v_mul_f32 v46, v46, v6
    v_exp_f32 v46, v46
    v_sub_f32 v47, v47, v14
    v_mul_f32 v47, v47, v6
    v_exp_f32 v47, v47
    v_sub_f32 v48, v48, v14
    v_mul_f32 v48, v48, v6
    v_exp_f32 v48, v48
    v_sub_f32 v49, v49, v14
    v_mul_f32 v49, v49, v6
    v_exp_f32 v49, v49
    v_sub_f32 v50, v50, v14
    v_mul_f32 v50, v50, v6
    v_exp_f32 v50, v50
    v_sub_f32 v51, v51, v14
    v_mul_f32 v51, v51, v6
    v_exp_f32 v51, v51
    v_add_f32 v3, v16, v17
    v_add_f32 v3, v3, v18
    v_add_f32 v3, v3, v19
    v_add_f32 v3, v3, v20
    v_add_f32 v3, v3, v21
    v_add_f32 v3, v3, v22
    v_add_f32 v3, v3, v23
    v_add_f32 v3, v3, v24
    v_add_f32 v3, v3, v25
    v_add_f32 v3, v3, v26
    v_add_f32 v3, v3, v27
    v_add_f32 v3, v3, v28
    v_add_f32 v3, v3, v29
    v_add_f32 v3, v3, v30
    v_add_f32 v3, v3, v31
    v_add_f32 v3, v3, v32
    v_add_f32 v3, v3, v33
    v_add_f32 v3, v3, v34
    v_add_f32 v3, v3, v35
    v_add_f32 v3, v3, v36
    v_add_f32 v3, v3, v37
    v_add_f32 v3, v3, v38
    v_add_f32 v3, v3, v39
    v_add_f32 v3, v3, v40
    v_add_f32 v3, v3, v41
    v_add_f32 v3, v3, v42
    v_add_f32 v3, v3, v43
    v_add_f32 v3, v3, v44
    v_add_f32 v3, v3, v45
    v_add_f32 v3, v3, v46
    v_add_f32 v3, v3, v47
    v_add_f32 v3, v3, v48
    v_add_f32 v3, v3, v49
    v_add_f32 v3, v3, v50
    v_add_f32 v3, v3, v51
    s_lshl_b32 s74, s66, 7
    s_lshl_b32 s75, s64, 3
    s_add_u32 s74, s74, s75
    s_mul_i32 s74, s74, 1152
    s_waitcnt vmcnt(15)
    v_lshlrev_b32 v5, 16, v104
    v_and_b32 v6, 0xffff0000, v104
    v_lshlrev_b32 v7, 16, v105
    v_and_b32 v8, 0xffff0000, v105
    v_lshlrev_b32 v9, 16, v106
    v_and_b32 v10, 0xffff0000, v106
    v_lshlrev_b32 v11, 16, v107
    v_and_b32 v12, 0xffff0000, v107
    buffer_load_dwordx4 v[104:107], v1, s[36:39], s84 offen offset:0 nt
    v_mul_f32 v116, v16, v5
    v_mul_f32 v117, v16, v6
    v_mul_f32 v118, v16, v7
    v_mul_f32 v119, v16, v8
    v_mul_f32 v120, v16, v9
    v_mul_f32 v121, v16, v10
    v_mul_f32 v122, v16, v11
    v_mul_f32 v123, v16, v12
    s_waitcnt vmcnt(15)
    v_lshlrev_b32 v5, 16, v108
    v_and_b32 v6, 0xffff0000, v108
    v_lshlrev_b32 v7, 16, v109
    v_and_b32 v8, 0xffff0000, v109
    v_lshlrev_b32 v9, 16, v110
    v_and_b32 v10, 0xffff0000, v110
    v_lshlrev_b32 v11, 16, v111
    v_and_b32 v12, 0xffff0000, v111
    buffer_load_dwordx4 v[108:111], v1, s[36:39], s84 offen offset:1024 nt
    v_fmac_f32 v116, v17, v5
    v_fmac_f32 v117, v17, v6
    v_fmac_f32 v118, v17, v7
    v_fmac_f32 v119, v17, v8
    v_fmac_f32 v120, v17, v9
    v_fmac_f32 v121, v17, v10
    v_fmac_f32 v122, v17, v11
    v_fmac_f32 v123, v17, v12
    s_waitcnt vmcnt(15)
    v_lshlrev_b32 v5, 16, v112
    v_and_b32 v6, 0xffff0000, v112
    v_lshlrev_b32 v7, 16, v113
    v_and_b32 v8, 0xffff0000, v113
    v_lshlrev_b32 v9, 16, v114
    v_and_b32 v10, 0xffff0000, v114
    v_lshlrev_b32 v11, 16, v115
    v_and_b32 v12, 0xffff0000, v115
    buffer_load_dwordx4 v[112:115], v1, s[36:39], s84 offen offset:2048 nt
    v_fmac_f32 v116, v18, v5
    v_fmac_f32 v117, v18, v6
    v_fmac_f32 v118, v18, v7
    v_fmac_f32 v119, v18, v8
    v_fmac_f32 v120, v18, v9
    v_fmac_f32 v121, v18, v10
    v_fmac_f32 v122, v18, v11
    v_fmac_f32 v123, v18, v12
    s_waitcnt vmcnt(15)
    v_lshlrev_b32 v5, 16, v52
    v_and_b32 v6, 0xffff0000, v52
    v_lshlrev_b32 v7, 16, v53
    v_and_b32 v8, 0xffff0000, v53
    v_lshlrev_b32 v9, 16, v54
    v_and_b32 v10, 0xffff0000, v54
    v_lshlrev_b32 v11, 16, v55
    v_and_b32 v12, 0xffff0000, v55
    buffer_load_dwordx4 v[52:55], v1, s[36:39], s84 offen offset:3072 nt
    v_fmac_f32 v116, v19, v5
    v_fmac_f32 v117, v19, v6
    v_fmac_f32 v118, v19, v7
    v_fmac_f32 v119, v19, v8
    v_fmac_f32 v120, v19, v9
    v_fmac_f32 v121, v19, v10
    v_fmac_f32 v122, v19, v11
    v_fmac_f32 v123, v19, v12
    s_waitcnt vmcnt(15)
    v_lshlrev_b32 v5, 16, v56
    v_and_b32 v6, 0xffff0000, v56
    v_lshlrev_b32 v7, 16, v57
    v_and_b32 v8, 0xffff0000, v57
    v_lshlrev_b32 v9, 16, v58
    v_and_b32 v10, 0xffff0000, v58
    v_lshlrev_b32 v11, 16, v59
    v_and_b32 v12, 0xffff0000, v59
    buffer_load_dwordx4 v[56:59], v1, s[36:39], s85 offen nt
    v_fmac_f32 v116, v20, v5
    v_fmac_f32 v117, v20, v6
    v_fmac_f32 v118, v20, v7
    v_fmac_f32 v119, v20, v8
    v_fmac_f32 v120, v20, v9
    v_fmac_f32 v121, v20, v10
    v_fmac_f32 v122, v20, v11
    v_fmac_f32 v123, v20, v12
    s_waitcnt vmcnt(15)
    v_lshlrev_b32 v5, 16, v60
    v_and_b32 v6, 0xffff0000, v60
    v_lshlrev_b32 v7, 16, v61
    v_and_b32 v8, 0xffff0000, v61
    v_lshlrev_b32 v9, 16, v62
    v_and_b32 v10, 0xffff0000, v62
    v_lshlrev_b32 v11, 16, v63
    v_and_b32 v12, 0xffff0000, v63
    buffer_load_dwordx4 v[60:63], v1, s[36:39], s86 offen nt
    v_fmac_f32 v116, v21, v5
    v_fmac_f32 v117, v21, v6
    v_fmac_f32 v118, v21, v7
    v_fmac_f32 v119, v21, v8
    v_fmac_f32 v120, v21, v9
    v_fmac_f32 v121, v21, v10
    v_fmac_f32 v122, v21, v11
    v_fmac_f32 v123, v21, v12
    s_waitcnt vmcnt(15)
    v_lshlrev_b32 v5, 16, v64
    v_and_b32 v6, 0xffff0000, v64
    v_lshlrev_b32 v7, 16, v65
    v_and_b32 v8, 0xffff0000, v65
    v_lshlrev_b32 v9, 16, v66
    v_and_b32 v10, 0xffff0000, v66
    v_lshlrev_b32 v11, 16, v67
    v_and_b32 v12, 0xffff0000, v67
    buffer_load_dwordx4 v[64:67], v1, s[36:39], s87 offen nt
    v_fmac_f32 v116, v22, v5
    v_fmac_f32 v117, v22, v6
    v_fmac_f32 v118, v22, v7
    v_fmac_f32 v119, v22, v8
    v_fmac_f32 v120, v22, v9
    v_fmac_f32 v121, v22, v10
    v_fmac_f32 v122, v22, v11
    v_fmac_f32 v123, v22, v12
    s_waitcnt vmcnt(15)
    v_lshlrev_b32 v5, 16, v68
    v_and_b32 v6, 0xffff0000, v68
    v_lshlrev_b32 v7, 16, v69
    v_and_b32 v8, 0xffff0000, v69
    v_lshlrev_b32 v9, 16, v70
    v_and_b32 v10, 0xffff0000, v70
    v_lshlrev_b32 v11, 16, v71
    v_and_b32 v12, 0xffff0000, v71
    buffer_load_dwordx4 v[68:71], v1, s[36:39], s88 offen nt
    v_fmac_f32 v116, v23, v5
    v_fmac_f32 v117, v23, v6
    v_fmac_f32 v118, v23, v7
    v_fmac_f32 v119, v23, v8
    v_fmac_f32 v120, v23, v9
    v_fmac_f32 v121, v23, v10
    v_fmac_f32 v122, v23, v11
    v_fmac_f32 v123, v23, v12
    s_waitcnt vmcnt(15)
    v_lshlrev_b32 v5, 16, v72
    v_and_b32 v6, 0xffff0000, v72
    v_lshlrev_b32 v7, 16, v73
    v_and_b32 v8, 0xffff0000, v73
    v_lshlrev_b32 v9, 16, v74
    v_and_b32 v10, 0xffff0000, v74
    v_lshlrev_b32 v11, 16, v75
    v_and_b32 v12, 0xffff0000, v75
    buffer_load_dwordx4 v[72:75], v1, s[36:39], s89 offen nt
    v_fmac_f32 v116, v24, v5
    v_fmac_f32 v117, v24, v6
    v_fmac_f32 v118, v24, v7
    v_fmac_f32 v119, v24, v8
    v_fmac_f32 v120, v24, v9
    v_fmac_f32 v121, v24, v10
    v_fmac_f32 v122, v24, v11
    v_fmac_f32 v123, v24, v12
    s_waitcnt vmcnt(15)
    v_lshlrev_b32 v5, 16, v76
    v_and_b32 v6, 0xffff0000, v76
    v_lshlrev_b32 v7, 16, v77
    v_and_b32 v8, 0xffff0000, v77
    v_lshlrev_b32 v9, 16, v78
    v_and_b32 v10, 0xffff0000, v78
    v_lshlrev_b32 v11, 16, v79
    v_and_b32 v12, 0xffff0000, v79
    buffer_load_dwordx4 v[76:79], v1, s[36:39], s90 offen nt
    v_fmac_f32 v116, v25, v5
    v_fmac_f32 v117, v25, v6
    v_fmac_f32 v118, v25, v7
    v_fmac_f32 v119, v25, v8
    v_fmac_f32 v120, v25, v9
    v_fmac_f32 v121, v25, v10
    v_fmac_f32 v122, v25, v11
    v_fmac_f32 v123, v25, v12
    s_waitcnt vmcnt(15)
    v_lshlrev_b32 v5, 16, v80
    v_and_b32 v6, 0xffff0000, v80
    v_lshlrev_b32 v7, 16, v81
    v_and_b32 v8, 0xffff0000, v81
    v_lshlrev_b32 v9, 16, v82
    v_and_b32 v10, 0xffff0000, v82
    v_lshlrev_b32 v11, 16, v83
    v_and_b32 v12, 0xffff0000, v83
    buffer_load_dwordx4 v[80:83], v1, s[36:39], s91 offen nt
    v_fmac_f32 v116, v26, v5
    v_fmac_f32 v117, v26, v6
    v_fmac_f32 v118, v26, v7
    v_fmac_f32 v119, v26, v8
    v_fmac_f32 v120, v26, v9
    v_fmac_f32 v121, v26, v10
    v_fmac_f32 v122, v26, v11
    v_fmac_f32 v123, v26, v12
    s_waitcnt vmcnt(15)
    v_lshlrev_b32 v5, 16, v84
    v_and_b32 v6, 0xffff0000, v84
    v_lshlrev_b32 v7, 16, v85
    v_and_b32 v8, 0xffff0000, v85
    v_lshlrev_b32 v9, 16, v86
    v_and_b32 v10, 0xffff0000, v86
    v_lshlrev_b32 v11, 16, v87
    v_and_b32 v12, 0xffff0000, v87
    buffer_load_dwordx4 v[84:87], v1, s[36:39], s92 offen nt
    v_fmac_f32 v116, v27, v5
    v_fmac_f32 v117, v27, v6
    v_fmac_f32 v118, v27, v7
    v_fmac_f32 v119, v27, v8
    v_fmac_f32 v120, v27, v9
    v_fmac_f32 v121, v27, v10
    v_fmac_f32 v122, v27, v11
    v_fmac_f32 v123, v27, v12
    s_waitcnt vmcnt(15)
    v_lshlrev_b32 v5, 16, v88
    v_and_b32 v6, 0xffff0000, v88
    v_lshlrev_b32 v7, 16, v89
    v_and_b32 v8, 0xffff0000, v89
    v_lshlrev_b32 v9, 16, v90
    v_and_b32 v10, 0xffff0000, v90
    v_lshlrev_b32 v11, 16, v91
    v_and_b32 v12, 0xffff0000, v91
    buffer_load_dwordx4 v[88:91], v1, s[36:39], s93 offen nt
    v_fmac_f32 v116, v28, v5
    v_fmac_f32 v117, v28, v6
    v_fmac_f32 v118, v28, v7
    v_fmac_f32 v119, v28, v8
    v_fmac_f32 v120, v28, v9
    v_fmac_f32 v121, v28, v10
    v_fmac_f32 v122, v28, v11
    v_fmac_f32 v123, v28, v12
    s_waitcnt vmcnt(15)
    v_lshlrev_b32 v5, 16, v92
    v_and_b32 v6, 0xffff0000, v92
    v_lshlrev_b32 v7, 16, v93
    v_and_b32 v8, 0xffff0000, v93
    v_lshlrev_b32 v9, 16, v94
    v_and_b32 v10, 0xffff0000, v94
    v_lshlrev_b32 v11, 16, v95
    v_and_b32 v12, 0xffff0000, v95
    buffer_load_dwordx4 v[92:95], v1, s[36:39], s94 offen nt
    v_fmac_f32 v116, v29, v5
    v_fmac_f32 v117, v29, v6
    v_fmac_f32 v118, v29, v7
    v_fmac_f32 v119, v29, v8
    v_fmac_f32 v120, v29, v9
    v_fmac_f32 v121, v29, v10
    v_fmac_f32 v122, v29, v11
    v_fmac_f32 v123, v29, v12
    s_waitcnt vmcnt(15)
    v_lshlrev_b32 v5, 16, v96
    v_and_b32 v6, 0xffff0000, v96
    v_lshlrev_b32 v7, 16, v97
    v_and_b32 v8, 0xffff0000, v97
    v_lshlrev_b32 v9, 16, v98
    v_and_b32 v10, 0xffff0000, v98
    v_lshlrev_b32 v11, 16, v99
    v_and_b32 v12, 0xffff0000, v99
    buffer_load_dwordx4 v[96:99], v1, s[36:39], s95 offen nt
    v_fmac_f32 v116, v30, v5
    v_fmac_f32 v117, v30, v6
    v_fmac_f32 v118, v30, v7
    v_fmac_f32 v119, v30, v8
    v_fmac_f32 v120, v30, v9
    v_fmac_f32 v121, v30, v10
    v_fmac_f32 v122, v30, v11
    v_fmac_f32 v123, v30, v12
    s_waitcnt vmcnt(15)
    v_lshlrev_b32 v5, 16, v100
    v_and_b32 v6, 0xffff0000, v100
    v_lshlrev_b32 v7, 16, v101
    v_and_b32 v8, 0xffff0000, v101
    v_lshlrev_b32 v9, 16, v102
    v_and_b32 v10, 0xffff0000, v102
    v_lshlrev_b32 v11, 16, v103
    v_and_b32 v12, 0xffff0000, v103
    buffer_load_dwordx4 v[100:103], v1, s[36:39], s96 offen nt
    v_fmac_f32 v116, v31, v5
    v_fmac_f32 v117, v31, v6
    v_fmac_f32 v118, v31, v7
    v_fmac_f32 v119, v31, v8
    v_fmac_f32 v120, v31, v9
    v_fmac_f32 v121, v31, v10
    v_fmac_f32 v122, v31, v11
    v_fmac_f32 v123, v31, v12
    s_waitcnt vmcnt(15)
    v_lshlrev_b32 v5, 16, v104
    v_and_b32 v6, 0xffff0000, v104
    v_lshlrev_b32 v7, 16, v105
    v_and_b32 v8, 0xffff0000, v105
    v_lshlrev_b32 v9, 16, v106
    v_and_b32 v10, 0xffff0000, v106
    v_lshlrev_b32 v11, 16, v107
    v_and_b32 v12, 0xffff0000, v107
    buffer_load_dwordx4 v[104:107], v1, s[36:39], s97 offen nt
    v_fmac_f32 v116, v32, v5
    v_fmac_f32 v117, v32, v6
    v_fmac_f32 v118, v32, v7
    v_fmac_f32 v119, v32, v8
    v_fmac_f32 v120, v32, v9
    v_fmac_f32 v121, v32, v10
    v_fmac_f32 v122, v32, v11
    v_fmac_f32 v123, v32, v12
    s_waitcnt vmcnt(15)
    v_lshlrev_b32 v5, 16, v108
    v_and_b32 v6, 0xffff0000, v108
    v_lshlrev_b32 v7, 16, v109
    v_and_b32 v8, 0xffff0000, v109
    v_lshlrev_b32 v9, 16, v110
    v_and_b32 v10, 0xffff0000, v110
    v_lshlrev_b32 v11, 16, v111
    v_and_b32 v12, 0xffff0000, v111
    buffer_load_dwordx4 v[108:111], v1, s[36:39], s98 offen nt
    v_fmac_f32 v116, v33, v5
    v_fmac_f32 v117, v33, v6
    v_fmac_f32 v118, v33, v7
    v_fmac_f32 v119, v33, v8
    v_fmac_f32 v120, v33, v9
    v_fmac_f32 v121, v33, v10
    v_fmac_f32 v122, v33, v11
    v_fmac_f32 v123, v33, v12
    s_waitcnt vmcnt(15)
    v_lshlrev_b32 v5, 16, v112
    v_and_b32 v6, 0xffff0000, v112
    v_lshlrev_b32 v7, 16, v113
    v_and_b32 v8, 0xffff0000, v113
    v_lshlrev_b32 v9, 16, v114
    v_and_b32 v10, 0xffff0000, v114
    v_lshlrev_b32 v11, 16, v115
    v_and_b32 v12, 0xffff0000, v115
    buffer_load_dwordx4 v[112:115], v1, s[36:39], s99 offen nt
    v_fmac_f32 v116, v34, v5
    v_fmac_f32 v117, v34, v6
    v_fmac_f32 v118, v34, v7
    v_fmac_f32 v119, v34, v8
    v_fmac_f32 v120, v34, v9
    v_fmac_f32 v121, v34, v10
    v_fmac_f32 v122, v34, v11
    v_fmac_f32 v123, v34, v12
    s_waitcnt vmcnt(15)
    v_lshlrev_b32 v5, 16, v52
    v_and_b32 v6, 0xffff0000, v52
    v_lshlrev_b32 v7, 16, v53
    v_and_b32 v8, 0xffff0000, v53
    v_lshlrev_b32 v9, 16, v54
    v_and_b32 v10, 0xffff0000, v54
    v_lshlrev_b32 v11, 16, v55
    v_and_b32 v12, 0xffff0000, v55
    buffer_load_dwordx4 v[52:55], v1, s[36:39], s100 offen nt
    v_fmac_f32 v116, v35, v5
    v_fmac_f32 v117, v35, v6
    v_fmac_f32 v118, v35, v7
    v_fmac_f32 v119, v35, v8
    v_fmac_f32 v120, v35, v9
    v_fmac_f32 v121, v35, v10
    v_fmac_f32 v122, v35, v11
    v_fmac_f32 v123, v35, v12
    s_waitcnt vmcnt(15)
    v_lshlrev_b32 v5, 16, v56
    v_and_b32 v6, 0xffff0000, v56
    v_lshlrev_b32 v7, 16, v57
    v_and_b32 v8, 0xffff0000, v57
    v_lshlrev_b32 v9, 16, v58
    v_and_b32 v10, 0xffff0000, v58
    v_lshlrev_b32 v11, 16, v59
    v_and_b32 v12, 0xffff0000, v59
    buffer_load_dwordx4 v[56:59], v1, s[44:47], s74 offen
    s_add_u32 s74, s74, 1152
    v_fmac_f32 v116, v36, v5
    v_fmac_f32 v117, v36, v6
    v_fmac_f32 v118, v36, v7
    v_fmac_f32 v119, v36, v8
    v_fmac_f32 v120, v36, v9
    v_fmac_f32 v121, v36, v10
    v_fmac_f32 v122, v36, v11
    v_fmac_f32 v123, v36, v12
    s_waitcnt vmcnt(15)
    v_lshlrev_b32 v5, 16, v60
    v_and_b32 v6, 0xffff0000, v60
    v_lshlrev_b32 v7, 16, v61
    v_and_b32 v8, 0xffff0000, v61
    v_lshlrev_b32 v9, 16, v62
    v_and_b32 v10, 0xffff0000, v62
    v_lshlrev_b32 v11, 16, v63
    v_and_b32 v12, 0xffff0000, v63
    buffer_load_dwordx4 v[60:63], v1, s[44:47], s74 offen
    s_add_u32 s74, s74, 1152
    v_fmac_f32 v116, v37, v5
    v_fmac_f32 v117, v37, v6
    v_fmac_f32 v118, v37, v7
    v_fmac_f32 v119, v37, v8
    v_fmac_f32 v120, v37, v9
    v_fmac_f32 v121, v37, v10
    v_fmac_f32 v122, v37, v11
    v_fmac_f32 v123, v37, v12
    s_waitcnt vmcnt(15)
    v_lshlrev_b32 v5, 16, v64
    v_and_b32 v6, 0xffff0000, v64
    v_lshlrev_b32 v7, 16, v65
    v_and_b32 v8, 0xffff0000, v65
    v_lshlrev_b32 v9, 16, v66
    v_and_b32 v10, 0xffff0000, v66
    v_lshlrev_b32 v11, 16, v67
    v_and_b32 v12, 0xffff0000, v67
    buffer_load_dwordx4 v[64:67], v1, s[44:47], s74 offen
    s_add_u32 s74, s74, 1152
    v_fmac_f32 v116, v38, v5
    v_fmac_f32 v117, v38, v6
    v_fmac_f32 v118, v38, v7
    v_fmac_f32 v119, v38, v8
    v_fmac_f32 v120, v38, v9
    v_fmac_f32 v121, v38, v10
    v_fmac_f32 v122, v38, v11
    v_fmac_f32 v123, v38, v12
    s_waitcnt vmcnt(15)
    v_lshlrev_b32 v5, 16, v68
    v_and_b32 v6, 0xffff0000, v68
    v_lshlrev_b32 v7, 16, v69
    v_and_b32 v8, 0xffff0000, v69
    v_lshlrev_b32 v9, 16, v70
    v_and_b32 v10, 0xffff0000, v70
    v_lshlrev_b32 v11, 16, v71
    v_and_b32 v12, 0xffff0000, v71
    buffer_load_dwordx4 v[68:71], v1, s[44:47], s74 offen
    s_add_u32 s74, s74, 1152
    v_fmac_f32 v116, v39, v5
    v_fmac_f32 v117, v39, v6
    v_fmac_f32 v118, v39, v7
    v_fmac_f32 v119, v39, v8
    v_fmac_f32 v120, v39, v9
    v_fmac_f32 v121, v39, v10
    v_fmac_f32 v122, v39, v11
    v_fmac_f32 v123, v39, v12
    s_waitcnt vmcnt(15)
    v_lshlrev_b32 v5, 16, v72
    v_and_b32 v6, 0xffff0000, v72
    v_lshlrev_b32 v7, 16, v73
    v_and_b32 v8, 0xffff0000, v73
    v_lshlrev_b32 v9, 16, v74
    v_and_b32 v10, 0xffff0000, v74
    v_lshlrev_b32 v11, 16, v75
    v_and_b32 v12, 0xffff0000, v75
    buffer_load_dwordx4 v[72:75], v1, s[44:47], s74 offen
    s_add_u32 s74, s74, 1152
    v_fmac_f32 v116, v40, v5
    v_fmac_f32 v117, v40, v6
    v_fmac_f32 v118, v40, v7
    v_fmac_f32 v119, v40, v8
    v_fmac_f32 v120, v40, v9
    v_fmac_f32 v121, v40, v10
    v_fmac_f32 v122, v40, v11
    v_fmac_f32 v123, v40, v12
    s_waitcnt vmcnt(15)
    v_lshlrev_b32 v5, 16, v76
    v_and_b32 v6, 0xffff0000, v76
    v_lshlrev_b32 v7, 16, v77
    v_and_b32 v8, 0xffff0000, v77
    v_lshlrev_b32 v9, 16, v78
    v_and_b32 v10, 0xffff0000, v78
    v_lshlrev_b32 v11, 16, v79
    v_and_b32 v12, 0xffff0000, v79
    buffer_load_dwordx4 v[76:79], v1, s[44:47], s74 offen
    s_add_u32 s74, s74, 1152
    v_fmac_f32 v116, v41, v5
    v_fmac_f32 v117, v41, v6
    v_fmac_f32 v118, v41, v7
    v_fmac_f32 v119, v41, v8
    v_fmac_f32 v120, v41, v9
    v_fmac_f32 v121, v41, v10
    v_fmac_f32 v122, v41, v11
    v_fmac_f32 v123, v41, v12
    s_waitcnt vmcnt(15)
    v_lshlrev_b32 v5, 16, v80
    v_and_b32 v6, 0xffff0000, v80
    v_lshlrev_b32 v7, 16, v81
    v_and_b32 v8, 0xffff0000, v81
    v_lshlrev_b32 v9, 16, v82
    v_and_b32 v10, 0xffff0000, v82
    v_lshlrev_b32 v11, 16, v83
    v_and_b32 v12, 0xffff0000, v83
    buffer_load_dwordx4 v[80:83], v1, s[44:47], s74 offen
    s_add_u32 s74, s74, 1152
    v_fmac_f32 v116, v42, v5
    v_fmac_f32 v117, v42, v6
    v_fmac_f32 v118, v42, v7
    v_fmac_f32 v119, v42, v8
    v_fmac_f32 v120, v42, v9
    v_fmac_f32 v121, v42, v10
    v_fmac_f32 v122, v42, v11
    v_fmac_f32 v123, v42, v12
    s_waitcnt vmcnt(15)
    v_lshlrev_b32 v5, 16, v84
    v_and_b32 v6, 0xffff0000, v84
    v_lshlrev_b32 v7, 16, v85
    v_and_b32 v8, 0xffff0000, v85
    v_lshlrev_b32 v9, 16, v86
    v_and_b32 v10, 0xffff0000, v86
    v_lshlrev_b32 v11, 16, v87
    v_and_b32 v12, 0xffff0000, v87
    buffer_load_dwordx4 v[84:87], v1, s[44:47], s74 offen
    s_add_u32 s74, s74, 1152
    v_fmac_f32 v116, v43, v5
    v_fmac_f32 v117, v43, v6
    v_fmac_f32 v118, v43, v7
    v_fmac_f32 v119, v43, v8
    v_fmac_f32 v120, v43, v9
    v_fmac_f32 v121, v43, v10
    v_fmac_f32 v122, v43, v11
    v_fmac_f32 v123, v43, v12
    s_waitcnt vmcnt(15)
    v_lshlrev_b32 v5, 16, v88
    v_and_b32 v6, 0xffff0000, v88
    v_lshlrev_b32 v7, 16, v89
    v_and_b32 v8, 0xffff0000, v89
    v_lshlrev_b32 v9, 16, v90
    v_and_b32 v10, 0xffff0000, v90
    v_lshlrev_b32 v11, 16, v91
    v_and_b32 v12, 0xffff0000, v91
    s_sub_u32 s74, s74, 9216
    buffer_load_dwordx4 v[88:91], v13, s[44:47], s74 offen
    v_fmac_f32 v116, v44, v5
    v_fmac_f32 v117, v44, v6
    v_fmac_f32 v118, v44, v7
    v_fmac_f32 v119, v44, v8
    v_fmac_f32 v120, v44, v9
    v_fmac_f32 v121, v44, v10
    v_fmac_f32 v122, v44, v11
    v_fmac_f32 v123, v44, v12
    s_waitcnt vmcnt(15)
    v_lshlrev_b32 v5, 16, v92
    v_and_b32 v6, 0xffff0000, v92
    v_lshlrev_b32 v7, 16, v93
    v_and_b32 v8, 0xffff0000, v93
    v_lshlrev_b32 v9, 16, v94
    v_and_b32 v10, 0xffff0000, v94
    v_lshlrev_b32 v11, 16, v95
    v_and_b32 v12, 0xffff0000, v95
    v_fmac_f32 v116, v45, v5
    v_fmac_f32 v117, v45, v6
    v_fmac_f32 v118, v45, v7
    v_fmac_f32 v119, v45, v8
    v_fmac_f32 v120, v45, v9
    v_fmac_f32 v121, v45, v10
    v_fmac_f32 v122, v45, v11
    v_fmac_f32 v123, v45, v12
    s_waitcnt vmcnt(14)
    v_lshlrev_b32 v5, 16, v96
    v_and_b32 v6, 0xffff0000, v96
    v_lshlrev_b32 v7, 16, v97
    v_and_b32 v8, 0xffff0000, v97
    v_lshlrev_b32 v9, 16, v98
    v_and_b32 v10, 0xffff0000, v98
    v_lshlrev_b32 v11, 16, v99
    v_and_b32 v12, 0xffff0000, v99
    v_fmac_f32 v116, v46, v5
    v_fmac_f32 v117, v46, v6
    v_fmac_f32 v118, v46, v7
    v_fmac_f32 v119, v46, v8
    v_fmac_f32 v120, v46, v9
    v_fmac_f32 v121, v46, v10
    v_fmac_f32 v122, v46, v11
    v_fmac_f32 v123, v46, v12
    s_waitcnt vmcnt(13)
    v_lshlrev_b32 v5, 16, v100
    v_and_b32 v6, 0xffff0000, v100
    v_lshlrev_b32 v7, 16, v101
    v_and_b32 v8, 0xffff0000, v101
    v_lshlrev_b32 v9, 16, v102
    v_and_b32 v10, 0xffff0000, v102
    v_lshlrev_b32 v11, 16, v103
    v_and_b32 v12, 0xffff0000, v103
    v_fmac_f32 v116, v47, v5
    v_fmac_f32 v117, v47, v6
    v_fmac_f32 v118, v47, v7
    v_fmac_f32 v119, v47, v8
    v_fmac_f32 v120, v47, v9
    v_fmac_f32 v121, v47, v10
    v_fmac_f32 v122, v47, v11
    v_fmac_f32 v123, v47, v12
    s_waitcnt vmcnt(12)
    v_lshlrev_b32 v5, 16, v104
    v_and_b32 v6, 0xffff0000, v104
    v_lshlrev_b32 v7, 16, v105
    v_and_b32 v8, 0xffff0000, v105
    v_lshlrev_b32 v9, 16, v106
    v_and_b32 v10, 0xffff0000, v106
    v_lshlrev_b32 v11, 16, v107
    v_and_b32 v12, 0xffff0000, v107
    v_fmac_f32 v116, v48, v5
    v_fmac_f32 v117, v48, v6
    v_fmac_f32 v118, v48, v7
    v_fmac_f32 v119, v48, v8
    v_fmac_f32 v120, v48, v9
    v_fmac_f32 v121, v48, v10
    v_fmac_f32 v122, v48, v11
    v_fmac_f32 v123, v48, v12
    s_waitcnt vmcnt(11)
    v_lshlrev_b32 v5, 16, v108
    v_and_b32 v6, 0xffff0000, v108
    v_lshlrev_b32 v7, 16, v109
    v_and_b32 v8, 0xffff0000, v109
    v_lshlrev_b32 v9, 16, v110
    v_and_b32 v10, 0xffff0000, v110
    v_lshlrev_b32 v11, 16, v111
    v_and_b32 v12, 0xffff0000, v111
    v_fmac_f32 v116, v49, v5
    v_fmac_f32 v117, v49, v6
    v_fmac_f32 v118, v49, v7
    v_fmac_f32 v119, v49, v8
    v_fmac_f32 v120, v49, v9
    v_fmac_f32 v121, v49, v10
    v_fmac_f32 v122, v49, v11
    v_fmac_f32 v123, v49, v12
    s_waitcnt vmcnt(10)
    v_lshlrev_b32 v5, 16, v112
    v_and_b32 v6, 0xffff0000, v112
    v_lshlrev_b32 v7, 16, v113
    v_and_b32 v8, 0xffff0000, v113
    v_lshlrev_b32 v9, 16, v114
    v_and_b32 v10, 0xffff0000, v114
    v_lshlrev_b32 v11, 16, v115
    v_and_b32 v12, 0xffff0000, v115
    v_fmac_f32 v116, v50, v5
    v_fmac_f32 v117, v50, v6
    v_fmac_f32 v118, v50, v7
    v_fmac_f32 v119, v50, v8
    v_fmac_f32 v120, v50, v9
    v_fmac_f32 v121, v50, v10
    v_fmac_f32 v122, v50, v11
    v_fmac_f32 v123, v50, v12
    s_waitcnt vmcnt(9)
    v_lshlrev_b32 v5, 16, v52
    v_and_b32 v6, 0xffff0000, v52
    v_lshlrev_b32 v7, 16, v53
    v_and_b32 v8, 0xffff0000, v53
    v_lshlrev_b32 v9, 16, v54
    v_and_b32 v10, 0xffff0000, v54
    v_lshlrev_b32 v11, 16, v55
    v_and_b32 v12, 0xffff0000, v55
    v_fmac_f32 v116, v51, v5
    v_fmac_f32 v117, v51, v6
    v_fmac_f32 v118, v51, v7
    v_fmac_f32 v119, v51, v8
    v_fmac_f32 v120, v51, v9
    v_fmac_f32 v121, v51, v10
    v_fmac_f32 v122, v51, v11
    v_fmac_f32 v123, v51, v12
    v_permlane32_swap_b32 v116, v117
    v_permlane32_swap_b32 v118, v119
    v_add_f32 v116, v116, v117
    v_add_f32 v118, v118, v119
    s_nop 1
    v_permlane16_swap_b32 v116, v118
    v_add_f32 v116, v116, v118
    v_permlane32_swap_b32 v120, v121
    v_permlane32_swap_b32 v122, v123
    v_add_f32 v120, v120, v121
    v_add_f32 v122, v122, v123
    s_nop 1
    v_permlane16_swap_b32 v120, v122
    v_add_f32 v120, v120, v122
    v_mov_b32 v5, v3
    s_nop 1
    v_permlane32_swap_b32 v3, v5
    v_add_f32 v3, v3, v5
    v_mov_b32 v5, v3
    s_nop 1
    v_permlane16_swap_b32 v3, v5
    v_add_f32 v3, v3, v5
    v_lshl_add_u32 v5, v4, 3, v15
    v_lshlrev_b32 v5, 2, v5
    s_mul_i32 s73, s64, 528
    v_add_u32 v5, s73, v5
    ds_write_b32 v5, v116 offset:13056
    ds_write_b32 v5, v120 offset:13072
    s_lshl_b32 s73, s64, 2
    v_mov_b32 v6, s73
    ds_write_b32 v6, v3 offset:12864
    s_waitcnt lgkmcnt(0)
    s_barrier
    v_and_b32 v5, 7, v2
    v_mul_u32_u24 v5, 528, v5
    v_lshrrev_b32 v6, 3, v2
    v_lshl_add_u32 v5, v6, 2, v5
    s_lshl_b32 s73, s64, 5
    v_add_u32 v5, s73, v5
    ds_read_b32 v6, v5 offset:13056
    ds_read_b32 v7, v5 offset:17280
    s_waitcnt lgkmcnt(0)
    v_add_f32 v16, v6, v7
    s_nop 1
    v_add_f32_dpp v16, v16, v16 quad_perm:[1,0,3,2] row_mask:0xf bank_mask:0xf
    s_nop 1
    v_add_f32_dpp v16, v16, v16 quad_perm:[2,3,0,1] row_mask:0xf bank_mask:0xf
    s_nop 1
    v_add_f32_dpp v16, v16, v16 row_half_mirror row_mask:0xf bank_mask:0xf
    s_nop 0
    v_readlane_b32 s88, v16, 0
    v_readlane_b32 s89, v16, 8
    v_readlane_b32 s90, v16, 16
    v_readlane_b32 s91, v16, 24
    v_readlane_b32 s92, v16, 32
    v_readlane_b32 s93, v16, 40
    v_readlane_b32 s94, v16, 48
    v_readlane_b32 s95, v16, 56
    s_waitcnt vmcnt(0)
    v_lshlrev_b32 v5, 16, v56
    v_and_b32 v6, 0xffff0000, v56
    v_lshlrev_b32 v7, 16, v57
    v_and_b32 v8, 0xffff0000, v57
    v_lshlrev_b32 v9, 16, v58
    v_and_b32 v10, 0xffff0000, v58
    v_lshlrev_b32 v11, 16, v59
    v_and_b32 v12, 0xffff0000, v59
    v_mul_f32 v116, s88, v5
    v_mul_f32 v117, s88, v6
    v_mul_f32 v118, s88, v7
    v_mul_f32 v119, s88, v8
    v_mul_f32 v120, s88, v9
    v_mul_f32 v121, s88, v10
    v_mul_f32 v122, s88, v11
    v_mul_f32 v123, s88, v12
    v_lshlrev_b32 v5, 16, v60
    v_and_b32 v6, 0xffff0000, v60
    v_lshlrev_b32 v7, 16, v61
    v_and_b32 v8, 0xffff0000, v61
    v_lshlrev_b32 v9, 16, v62
    v_and_b32 v10, 0xffff0000, v62
    v_lshlrev_b32 v11, 16, v63
    v_and_b32 v12, 0xffff0000, v63
    v_fmac_f32 v116, s89, v5
    v_fmac_f32 v117, s89, v6
    v_fmac_f32 v118, s89, v7
    v_fmac_f32 v119, s89, v8
    v_fmac_f32 v120, s89, v9
    v_fmac_f32 v121, s89, v10
    v_fmac_f32 v122, s89, v11
    v_fmac_f32 v123, s89, v12
    v_lshlrev_b32 v5, 16, v64
    v_and_b32 v6, 0xffff0000, v64
    v_lshlrev_b32 v7, 16, v65
    v_and_b32 v8, 0xffff0000, v65
    v_lshlrev_b32 v9, 16, v66
    v_and_b32 v10, 0xffff0000, v66
    v_lshlrev_b32 v11, 16, v67
    v_and_b32 v12, 0xffff0000, v67
    v_fmac_f32 v116, s90, v5
    v_fmac_f32 v117, s90, v6
    v_fmac_f32 v118, s90, v7
    v_fmac_f32 v119, s90, v8
    v_fmac_f32 v120, s90, v9
    v_fmac_f32 v121, s90, v10
    v_fmac_f32 v122, s90, v11
    v_fmac_f32 v123, s90, v12
    v_lshlrev_b32 v5, 16, v68
    v_and_b32 v6, 0xffff0000, v68
    v_lshlrev_b32 v7, 16, v69
    v_and_b32 v8, 0xffff0000, v69
    v_lshlrev_b32 v9, 16, v70
    v_and_b32 v10, 0xffff0000, v70
    v_lshlrev_b32 v11, 16, v71
    v_and_b32 v12, 0xffff0000, v71
    v_fmac_f32 v116, s91, v5
    v_fmac_f32 v117, s91, v6
    v_fmac_f32 v118, s91, v7
    v_fmac_f32 v119, s91, v8
    v_fmac_f32 v120, s91, v9
    v_fmac_f32 v121, s91, v10
    v_fmac_f32 v122, s91, v11
    v_fmac_f32 v123, s91, v12
    v_lshlrev_b32 v5, 16, v72
    v_and_b32 v6, 0xffff0000, v72
    v_lshlrev_b32 v7, 16, v73
    v_and_b32 v8, 0xffff0000, v73
    v_lshlrev_b32 v9, 16, v74
    v_and_b32 v10, 0xffff0000, v74
    v_lshlrev_b32 v11, 16, v75
    v_and_b32 v12, 0xffff0000, v75
    v_fmac_f32 v116, s92, v5
    v_fmac_f32 v117, s92, v6
    v_fmac_f32 v118, s92, v7
    v_fmac_f32 v119, s92, v8
    v_fmac_f32 v120, s92, v9
    v_fmac_f32 v121, s92, v10
    v_fmac_f32 v122, s92, v11
    v_fmac_f32 v123, s92, v12
    v_lshlrev_b32 v5, 16, v76
    v_and_b32 v6, 0xffff0000, v76
    v_lshlrev_b32 v7, 16, v77
    v_and_b32 v8, 0xffff0000, v77
    v_lshlrev_b32 v9, 16, v78
    v_and_b32 v10, 0xffff0000, v78
    v_lshlrev_b32 v11, 16, v79
    v_and_b32 v12, 0xffff0000, v79
    v_fmac_f32 v116, s93, v5
    v_fmac_f32 v117, s93, v6
    v_fmac_f32 v118, s93, v7
    v_fmac_f32 v119, s93, v8
    v_fmac_f32 v120, s93, v9
    v_fmac_f32 v121, s93, v10
    v_fmac_f32 v122, s93, v11
    v_fmac_f32 v123, s93, v12
    v_lshlrev_b32 v5, 16, v80
    v_and_b32 v6, 0xffff0000, v80
    v_lshlrev_b32 v7, 16, v81
    v_and_b32 v8, 0xffff0000, v81
    v_lshlrev_b32 v9, 16, v82
    v_and_b32 v10, 0xffff0000, v82
    v_lshlrev_b32 v11, 16, v83
    v_and_b32 v12, 0xffff0000, v83
    v_fmac_f32 v116, s94, v5
    v_fmac_f32 v117, s94, v6
    v_fmac_f32 v118, s94, v7
    v_fmac_f32 v119, s94, v8
    v_fmac_f32 v120, s94, v9
    v_fmac_f32 v121, s94, v10
    v_fmac_f32 v122, s94, v11
    v_fmac_f32 v123, s94, v12
    v_lshlrev_b32 v5, 16, v84
    v_and_b32 v6, 0xffff0000, v84
    v_lshlrev_b32 v7, 16, v85
    v_and_b32 v8, 0xffff0000, v85
    v_lshlrev_b32 v9, 16, v86
    v_and_b32 v10, 0xffff0000, v86
    v_lshlrev_b32 v11, 16, v87
    v_and_b32 v12, 0xffff0000, v87
    v_fmac_f32 v116, s95, v5
    v_fmac_f32 v117, s95, v6
    v_fmac_f32 v118, s95, v7
    v_fmac_f32 v119, s95, v8
    v_fmac_f32 v120, s95, v9
    v_fmac_f32 v121, s95, v10
    v_fmac_f32 v122, s95, v11
    v_fmac_f32 v123, s95, v12
    s_mul_i32 s73, s64, 2304
    s_add_u32 s73, s73, 21504
    v_lshlrev_b32 v17, 5, v2
    v_add_u32 v17, s73, v17
    ds_write_b128 v17, v[116:119]
    ds_write_b128 v17, v[120:123] offset:16
    v_lshlrev_b32 v5, 16, v88
    v_and_b32 v6, 0xffff0000, v88
    v_mul_f32 v20, v16, v5
    v_mul_f32 v21, v16, v6
    v_lshlrev_b32 v5, 16, v89
    v_and_b32 v6, 0xffff0000, v89
    v_mul_f32 v22, v16, v5
    v_mul_f32 v23, v16, v6
    v_lshlrev_b32 v5, 16, v90
    v_and_b32 v6, 0xffff0000, v90
    v_mul_f32 v24, v16, v5
    v_mul_f32 v25, v16, v6
    v_lshlrev_b32 v5, 16, v91
    v_and_b32 v6, 0xffff0000, v91
    v_mul_f32 v26, v16, v5
    v_mul_f32 v27, v16, v6
    v_permlane32_swap_b32 v20, v21
    v_permlane32_swap_b32 v22, v23
    v_add_f32 v20, v20, v21
    v_add_f32 v22, v22, v23
    s_nop 1
    v_permlane16_swap_b32 v20, v22
    v_add_f32 v20, v20, v22
    v_permlane32_swap_b32 v24, v25
    v_permlane32_swap_b32 v26, v27
    v_add_f32 v24, v24, v25
    v_add_f32 v26, v26, v27
    s_nop 1
    v_permlane16_swap_b32 v24, v26
    v_add_f32 v24, v24, v26
    v_add_f32_dpp v20, v20, v20 row_ror:8 row_mask:0xf bank_mask:0xf
    s_nop 0
    v_add_f32_dpp v24, v24, v24 row_ror:8 row_mask:0xf bank_mask:0xf
    v_and_b32 v5, 7, v4
    v_lshl_add_u32 v5, v5, 3, v15
    v_lshlrev_b32 v5, 2, v5
    v_add_u32 v5, s73, v5
    ds_write_b32 v5, v20 offset:2048
    ds_write_b32 v5, v24 offset:2064
    s_waitcnt lgkmcnt(0)
    s_barrier
    s_cmp_ge_u32 s64, 9
    s_cbranch_scc1 L_k1_fin2
    v_lshlrev_b32 v5, 2, v0
    ds_read_b32 v16, v5 offset:21504
    ds_read_b32 v17, v5 offset:23808
    ds_read_b32 v18, v5 offset:26112
    ds_read_b32 v19, v5 offset:28416
    ds_read_b32 v20, v5 offset:30720
    ds_read_b32 v21, v5 offset:33024
    ds_read_b32 v22, v5 offset:35328
    ds_read_b32 v23, v5 offset:37632
    ds_read_b32 v24, v5 offset:39936
    ds_read_b32 v25, v5 offset:42240
    ds_read_b32 v26, v5 offset:44544
    ds_read_b32 v27, v5 offset:46848
    ds_read_b32 v28, v5 offset:49152
    ds_read_b32 v29, v5 offset:51456
    ds_read_b32 v30, v5 offset:53760
    ds_read_b32 v31, v5 offset:56064
    v_lshrrev_b32 v7, 4, v0
    v_lshlrev_b32 v7, 15, v7
    v_and_b32 v8, 15, v0
    v_lshl_add_u32 v7, v8, 2, v7
    s_lshl_b32 s73, s65, 6
    s_waitcnt lgkmcnt(0)
    v_add_f32 v9, v16, v17
    v_add_f32 v9, v9, v18
    v_add_f32 v9, v9, v19
    v_add_f32 v9, v9, v20
    v_add_f32 v9, v9, v21
    v_add_f32 v9, v9, v22
    v_add_f32 v9, v9, v23
    v_add_f32 v9, v9, v24
    v_add_f32 v9, v9, v25
    v_add_f32 v9, v9, v26
    v_add_f32 v9, v9, v27
    v_add_f32 v9, v9, v28
    v_add_f32 v9, v9, v29
    v_add_f32 v9, v9, v30
    v_add_f32 v9, v9, v31
    buffer_store_dword v9, v7, s[60:63], s73 offen
    s_cmp_eq_u32 s67, -1
    s_cbranch_scc1 L_k1_end
    v_add_u32 v6, 58368, v5
    ds_read_b32 v32, v6 offset:0
    ds_read_b32 v33, v6 offset:2304
    ds_read_b32 v34, v6 offset:4608
    ds_read_b32 v35, v6 offset:6912
    ds_read_b32 v36, v6 offset:9216
    ds_read_b32 v37, v6 offset:11520
    ds_read_b32 v38, v6 offset:13824
    ds_read_b32 v39, v6 offset:16128
    ds_read_b32 v40, v6 offset:18432
    ds_read_b32 v41, v6 offset:20736
    ds_read_b32 v42, v6 offset:23040
    ds_read_b32 v43, v6 offset:25344
    ds_read_b32 v44, v6 offset:27648
    ds_read_b32 v45, v6 offset:29952
    ds_read_b32 v46, v6 offset:32256
    ds_read_b32 v47, v6 offset:34560
    s_lshl_b32 s74, s67, 6
    s_add_u32 s74, s74, 16384
    s_waitcnt lgkmcnt(0)
    v_add_f32 v10, v32, v33
    v_add_f32 v10, v10, v34
    v_add_f32 v10, v10, v35
    v_add_f32 v10, v10, v36
    v_add_f32 v10, v10, v37
    v_add_f32 v10, v10, v38
    v_add_f32 v10, v10, v39
    v_add_f32 v10, v10, v40
    v_add_f32 v10, v10, v41
    v_add_f32 v10, v10, v42
    v_add_f32 v10, v10, v43
    v_add_f32 v10, v10, v44
    v_add_f32 v10, v10, v45
    v_add_f32 v10, v10, v46
    v_add_f32 v10, v10, v47
    buffer_store_dword v10, v7, s[60:63], s74 offen
    s_branch L_k1_end
L_k1_fin2:
    s_nop 4
    s_cmp_lg_u32 s64, 9
    s_cbranch_scc1 L_k1_end
    v_and_b32 v5, 15, v2
    v_lshlrev_b32 v5, 2, v5
    ds_read_b32 v15, v5 offset:12864
    s_waitcnt lgkmcnt(0)
    v_add_f32_dpp v15, v15, v15 row_ror:8 row_mask:0xf bank_mask:0xf
    s_nop 1
    v_add_f32_dpp v15, v15, v15 row_ror:4 row_mask:0xf bank_mask:0xf
    s_nop 1
    v_add_f32_dpp v15, v15, v15 row_ror:2 row_mask:0xf bank_mask:0xf
    s_nop 1
    v_add_f32_dpp v15, v15, v15 row_ror:1 row_mask:0xf bank_mask:0xf
    s_lshl_b32 s73, s65, 3
    s_add_u32 s73, s73, 1179648
    v_mov_b32 v6, 0
    s_mov_b64 exec, 1
    buffer_store_dwordx2 v[14:15], v6, s[60:63], s73 offen
L_k1_end:
    s_nop 4
    s_endpgm
.globl psum_final_kernel
.p2align 8
.type psum_final_kernel,@function
psum_final_kernel:
    s_cmp_ge_u32 s2, 144
    s_cbranch_scc1 L_k2_end
    s_load_dwordx2 s[4:5], s[0:1], 0
    s_load_dwordx2 s[6:7], s[0:1], 72
    s_load_dwordx2 s[8:9], s[0:1], 88
    v_lshlrev_b32 v1, 6, v0
    v_lshlrev_b32 v2, 3, v0
    s_lshr_b32 s10, s2, 2
    s_lshl_b32 s10, s10, 15
    s_and_b32 s11, s2, 3
    s_lshl_b32 s11, s11, 4
    s_add_u32 s10, s10, s11
    v_mov_b32 v3, 0
    s_waitcnt lgkmcnt(0)
    s_mov_b32 s12, s4
    s_and_b32 s13, s5, 0xffff
    s_mov_b32 s14, 1152
    s_mov_b32 s15, 0x00020000
    s_mov_b32 s16, s6
    s_and_b32 s17, s7, 0xffff
    s_mov_b32 s18, 1152
    s_mov_b32 s19, 0x00020000
    s_mov_b32 s20, s8
    s_and_b32 s21, s9, 0xffff
    s_mov_b32 s22, 1181696
    s_mov_b32 s23, 0x00020000
    s_mov_b32 s11, 1179648
    buffer_load_dwordx2 v[4:5], v2, s[20:23], s11 offen offset:0
    buffer_load_dwordx2 v[6:7], v2, s[20:23], s11 offen offset:512
    buffer_load_dwordx2 v[8:9], v2, s[20:23], s11 offen offset:1024
    buffer_load_dwordx2 v[10:11], v2, s[20:23], s11 offen offset:1536
    buffer_load_dwordx4 v[16:19], v1, s[20:23], s10 offen
    s_add_u32 s10, s10, 4096
    buffer_load_dwordx4 v[20:23], v1, s[20:23], s10 offen
    s_add_u32 s10, s10, 4096
    buffer_load_dwordx4 v[24:27], v1, s[20:23], s10 offen
    s_add_u32 s10, s10, 4096
    buffer_load_dwordx4 v[28:31], v1, s[20:23], s10 offen
    s_add_u32 s10, s10, 4096
    buffer_load_dwordx4 v[32:35], v1, s[20:23], s10 offen
    s_add_u32 s10, s10, 4096
    buffer_load_dwordx4 v[36:39], v1, s[20:23], s10 offen
    s_lshl_b32 s11, s2, 3
    buffer_load_dwordx2 v[60:61], v3, s[12:15], s11 offen
    v_cmp_gt_u32 vcc, 8, v0
    s_waitcnt vmcnt(7)
    v_mov_b32 v40, v4
    v_mov_b32 v41, v6
    v_mov_b32 v42, v8
    v_mov_b32 v43, v10
    v_max_f32_dpp v40, v40, v40 quad_perm:[1,0,3,2] row_mask:0xf bank_mask:0xf
    v_max_f32_dpp v41, v41, v41 quad_perm:[1,0,3,2] row_mask:0xf bank_mask:0xf
    v_max_f32_dpp v42, v42, v42 quad_perm:[1,0,3,2] row_mask:0xf bank_mask:0xf
    v_max_f32_dpp v43, v43, v43 quad_perm:[1,0,3,2] row_mask:0xf bank_mask:0xf
    v_max_f32_dpp v40, v40, v40 quad_perm:[2,3,0,1] row_mask:0xf bank_mask:0xf
    v_max_f32_dpp v41, v41, v41 quad_perm:[2,3,0,1] row_mask:0xf bank_mask:0xf
    v_max_f32_dpp v42, v42, v42 quad_perm:[2,3,0,1] row_mask:0xf bank_mask:0xf
    v_max_f32_dpp v43, v43, v43 quad_perm:[2,3,0,1] row_mask:0xf bank_mask:0xf
    v_max_f32_dpp v40, v40, v40 row_half_mirror row_mask:0xf bank_mask:0xf
    v_max_f32_dpp v41, v41, v41 row_half_mirror row_mask:0xf bank_mask:0xf
    v_max_f32_dpp v42, v42, v42 row_half_mirror row_mask:0xf bank_mask:0xf
    v_max_f32_dpp v43, v43, v43 row_half_mirror row_mask:0xf bank_mask:0xf
    v_sub_f32 v44, v4, v40
    v_sub_f32 v45, v6, v41
    v_sub_f32 v46, v8, v42
    v_sub_f32 v47, v10, v43
    v_mul_f32 v44, 0x3fb8aa3b, v44
    v_mul_f32 v45, 0x3fb8aa3b, v45
    v_mul_f32 v46, 0x3fb8aa3b, v46
    v_mul_f32 v47, 0x3fb8aa3b, v47
    v_exp_f32 v44, v44
    v_exp_f32 v45, v45
    v_exp_f32 v46, v46
    v_exp_f32 v47, v47
    v_mul_f32 v40, v44, v5
    v_mul_f32 v41, v45, v7
    v_mul_f32 v42, v46, v9
    v_mul_f32 v43, v47, v11
    v_add_f32_dpp v40, v40, v40 quad_perm:[1,0,3,2] row_mask:0xf bank_mask:0xf
    v_add_f32_dpp v41, v41, v41 quad_perm:[1,0,3,2] row_mask:0xf bank_mask:0xf
    v_add_f32_dpp v42, v42, v42 quad_perm:[1,0,3,2] row_mask:0xf bank_mask:0xf
    v_add_f32_dpp v43, v43, v43 quad_perm:[1,0,3,2] row_mask:0xf bank_mask:0xf
    v_add_f32_dpp v40, v40, v40 quad_perm:[2,3,0,1] row_mask:0xf bank_mask:0xf
    v_add_f32_dpp v41, v41, v41 quad_perm:[2,3,0,1] row_mask:0xf bank_mask:0xf
    v_add_f32_dpp v42, v42, v42 quad_perm:[2,3,0,1] row_mask:0xf bank_mask:0xf
    v_add_f32_dpp v43, v43, v43 quad_perm:[2,3,0,1] row_mask:0xf bank_mask:0xf
    v_add_f32_dpp v40, v40, v40 row_half_mirror row_mask:0xf bank_mask:0xf
    v_add_f32_dpp v41, v41, v41 row_half_mirror row_mask:0xf bank_mask:0xf
    v_add_f32_dpp v42, v42, v42 row_half_mirror row_mask:0xf bank_mask:0xf
    v_add_f32_dpp v43, v43, v43 row_half_mirror row_mask:0xf bank_mask:0xf
    v_rcp_f32 v4, v40
    v_rcp_f32 v5, v41
    v_rcp_f32 v6, v42
    v_rcp_f32 v7, v43
    v_mul_f32 v8, v44, v4
    v_mul_f32 v9, v45, v5
    v_mul_f32 v10, v46, v6
    v_mul_f32 v11, v47, v7
    v_fma_f32 v12, -v8, v40, v44
    v_fma_f32 v13, -v9, v41, v45
    v_fma_f32 v14, -v10, v42, v46
    v_fma_f32 v15, -v11, v43, v47
    v_fma_f32 v12, v12, v4, v8
    v_fma_f32 v13, v13, v5, v9
    v_fma_f32 v14, v14, v6, v10
    v_fma_f32 v15, v15, v7, v11
    s_waitcnt vmcnt(6)
    v_mul_f32 v48, v12, v16
    v_mul_f32 v49, v12, v17
    v_mul_f32 v50, v12, v18
    v_mul_f32 v51, v12, v19
    s_waitcnt vmcnt(5)
    v_fmac_f32 v48, v13, v20
    v_fmac_f32 v49, v13, v21
    v_fmac_f32 v50, v13, v22
    v_fmac_f32 v51, v13, v23
    s_waitcnt vmcnt(4)
    v_fmac_f32 v48, v14, v24
    v_fmac_f32 v49, v14, v25
    v_fmac_f32 v50, v14, v26
    v_fmac_f32 v51, v14, v27
    s_waitcnt vmcnt(3)
    v_fmac_f32 v48, v15, v28
    v_fmac_f32 v49, v15, v29
    v_fmac_f32 v50, v15, v30
    v_fmac_f32 v51, v15, v31
    s_waitcnt vmcnt(2)
    v_mov_b32 v52, v32
    v_mov_b32 v53, v33
    v_mov_b32 v54, v34
    v_mov_b32 v55, v35
    s_waitcnt vmcnt(1)
    v_cndmask_b32 v36, 0, v36, vcc
    v_add_f32 v52, v52, v36
    v_cndmask_b32 v37, 0, v37, vcc
    v_add_f32 v53, v53, v37
    v_cndmask_b32 v38, 0, v38, vcc
    v_add_f32 v54, v54, v38
    v_cndmask_b32 v39, 0, v39, vcc
    v_add_f32 v55, v55, v39
    v_permlane32_swap_b32 v48, v49
    v_permlane32_swap_b32 v50, v51
    v_add_f32 v48, v48, v49
    v_add_f32 v50, v50, v51
    s_nop 1
    v_permlane16_swap_b32 v48, v50
    v_add_f32 v48, v48, v50
    v_permlane32_swap_b32 v52, v53
    v_permlane32_swap_b32 v54, v55
    v_add_f32 v52, v52, v53
    v_add_f32 v54, v54, v55
    s_nop 1
    v_permlane16_swap_b32 v52, v54
    v_add_f32 v52, v52, v54
    v_add_f32_dpp v48, v48, v48 row_ror:8 row_mask:0xf bank_mask:0xf
    s_nop 0
    v_add_f32_dpp v52, v52, v52 row_ror:8 row_mask:0xf bank_mask:0xf
    v_add_f32_dpp v48, v48, v48 row_ror:4 row_mask:0xf bank_mask:0xf
    s_nop 0
    v_add_f32_dpp v52, v52, v52 row_ror:4 row_mask:0xf bank_mask:0xf
    v_add_f32_dpp v48, v48, v48 row_ror:2 row_mask:0xf bank_mask:0xf
    s_nop 0
    v_add_f32_dpp v52, v52, v52 row_ror:2 row_mask:0xf bank_mask:0xf
    v_add_f32_dpp v48, v48, v48 row_ror:1 row_mask:0xf bank_mask:0xf
    s_nop 0
    v_add_f32_dpp v52, v52, v52 row_ror:1 row_mask:0xf bank_mask:0xf
    v_cvt_pk_bf16_f32 v48, v48, v48
    v_lshlrev_b32 v48, 16, v48
    v_cvt_pk_bf16_f32 v52, v52, v52
    v_lshlrev_b32 v52, 16, v52
    s_waitcnt vmcnt(0)
    v_lshrrev_b32 v4, 4, v0
    v_and_b32 v5, 1, v4
    v_cmp_eq_u32 vcc, 1, v5
    s_nop 1
    v_cndmask_b32 v6, v60, v61, vcc
    v_lshlrev_b32 v7, 16, v6
    v_and_b32 v8, 0xffff0000, v6
    v_cmp_lt_u32 vcc, 31, v0
    s_nop 1
    v_cndmask_b32 v6, v7, v8, vcc
    v_add_f32 v48, v6, v48
    v_cvt_pk_bf16_f32 v48, v48, v48
    v_lshlrev_b32 v48, 16, v48
    v_add_f32 v48, v48, v52
    v_cvt_pk_bf16_f32 v48, v48, v48
    v_lshlrev_b32 v5, 2, v5
    v_lshrrev_b32 v4, 1, v4
    v_lshl_add_u32 v5, v4, 1, v5
    s_mov_b32 s24, 0x00010001
    s_mov_b32 s25, 0x00010001
    s_mov_b64 exec, s[24:25]
    buffer_store_short v48, v5, s[16:19], s11 offen
L_k2_end:
    s_nop 4
    s_endpgm
.section .rodata,"a"
.p2align 6
.amdhsa_kernel parallel_sum__mha_block_cached__geglu_ffn__decode_kernel
  .amdhsa_next_free_vgpr 128
  .amdhsa_next_free_sgpr 102
  .amdhsa_accum_offset 128
  .amdhsa_group_segment_fixed_size 0
  .amdhsa_kernarg_size 96
  .amdhsa_user_sgpr_count 2
  .amdhsa_user_sgpr_kernarg_segment_ptr 1
  .amdhsa_system_sgpr_workgroup_id_x 1
.end_amdhsa_kernel
.p2align 6
.amdhsa_kernel psum_final_kernel
  .amdhsa_next_free_vgpr 64
  .amdhsa_next_free_sgpr 102
  .amdhsa_accum_offset 64
  .amdhsa_group_segment_fixed_size 0
  .amdhsa_kernarg_size 96
  .amdhsa_user_sgpr_count 2
  .amdhsa_user_sgpr_kernarg_segment_ptr 1
  .amdhsa_system_sgpr_workgroup_id_x 1
.end_amdhsa_kernel
```
